```python
import torch

def _softmax(x, axis=-1):
    return torch.softmax(x, dim=axis)
def _gelu(x):
    return torch.nn.functional.gelu(x, approximate="tanh")
def _silu(x):
    return torch.nn.functional.silu(x)
def _sigmoid(x):
    return torch.sigmoid(x)
def _layernorm(x, axis=-1, eps=1e-5):
    m = x.mean(dim=axis, keepdim=True)
    v = x.var(dim=axis, keepdim=True, unbiased=False)
    return (x - m) / torch.sqrt(v + eps)
def _scatter_add(tgt, idx, src, axis=0):
    return tgt.clone().index_add_(axis, idx, src)
def _segment_sum(src, seg, n):
    out = torch.zeros((n,) + src.shape[1:], dtype=src.dtype)
    return out.index_add_(0, seg, src)
def _pad(x, pw):
    flat = tuple(v for pair in reversed(pw) for v in pair)
    return torch.nn.functional.pad(x, flat)

kernel_name = 'gated_mix__sliding_block__mha_block__prompt'

def setup_inputs():

    _w = (lambda a: (lambda t: t.to(torch.bfloat16) if t.is_floating_point() else t)(torch.as_tensor(a)))
    def _A_setup():
        B, S, D = 1, 2048, 1024
        return {
            "x": _w((lambda *s: torch.randn(*s, dtype=torch.bfloat16) * 0.05)(B, S, D)),
            "wqkv": _w((lambda *s: torch.randn(*s, dtype=torch.bfloat16) * 0.8)(D, 3 * D)),
            "wo": _w((lambda *s: torch.randn(*s, dtype=torch.bfloat16) * 0.05)(D, D)),
        }
    _A_in = _A_setup()

    def _B_setup():
        B, S, D, H = 1, 2048, 1024, 32
        return {
            "x": _w((lambda *s: torch.randn(*s, dtype=torch.bfloat16) * 0.05)(B, S, D)),
            "wqkv": _w((lambda *s: torch.randn(*s, dtype=torch.bfloat16) * 0.8)(D, 3 * D)),
            "wo": _w((lambda *s: torch.randn(*s, dtype=torch.bfloat16) * 0.1)(D, D)),
        }
    _B_in = _B_setup()

    return {
        "A_x": _A_in["x"],
        "A_wqkv": _A_in["wqkv"],
        "A_wo": _A_in["wo"],
        "B_x": _B_in["x"],
        "B_wqkv": _B_in["wqkv"],
        "B_wo": _B_in["wo"],
        "gate_w": _w((lambda *s: torch.randn(*s, dtype=torch.bfloat16) * 0.05)(1024) * 16.0),
    }

def reference(A_x, A_wqkv, A_wo, B_x, B_wqkv, B_wo, gate_w):
    def _A_ref(x, wqkv, wo):
        B, S, D = x.shape
        H = 32; Dh = D // H; W = 256
        qkv = (lambda x, *d: x.permute(*d))((x @ wqkv).reshape(B, S, 3, H, Dh), 2, 0, 3, 1, 4)
        q, k, v = qkv[0], qkv[1], qkv[2]
        scores = torch.einsum("bhqd,bhkd->bhqk", q, k) * (Dh ** -0.5)
        idx = torch.arange(S)
        mask = (idx[:, None] - idx[None, :] >= 0) & (idx[:, None] - idx[None, :] < W)
        scores = torch.where(mask[None, None], scores, -1e9)
        p = _softmax(scores, axis=-1)
        o = torch.einsum("bhqk,bhkd->bhqd", p, v)
        return (lambda x, *d: x.permute(*d))(o, 0, 2, 1, 3).reshape(B, S, D) @ wo

    def _B_ref(x, wqkv, wo):
        B, S, D = x.shape
        H = 32
        Dh = D // H
        qkv = (lambda x, *d: x.permute(*d))((x @ wqkv).reshape(B, S, 3, H, Dh), 2, 0, 3, 1, 4)
        q, k, v = qkv[0], qkv[1], qkv[2]
        scores = torch.einsum("bhqd,bhkd->bhqk", q, k) * (Dh ** -0.5)
        p = _softmax(scores, axis=-1)
        o = torch.einsum("bhqk,bhkd->bhqd", p, v)
        return (lambda x, *d: x.permute(*d))(o, 0, 2, 1, 3).reshape(B, S, D) @ wo

    x = A_x
    g = _sigmoid((x * gate_w).sum(-1, keepdims=True))
    a = _A_ref(x, A_wqkv, A_wo)
    b = _B_ref(x, B_wqkv, B_wo)
    return g * a + (1 - g) * b
```

```asm
; @launch grid=(256,1,1) block=(512,1,1) lds=163840
.amdgcn_target "amdgcn-amd-amdhsa--gfx950"
.text
.globl gated_mix__sliding_block__mha_block__prompt_kernel
.p2align 8
.type gated_mix__sliding_block__mha_block__prompt_kernel,@function
gated_mix__sliding_block__mha_block__prompt_kernel:
    s_cmp_ge_u32 s2, 256
    s_cbranch_scc1 L_end
    s_load_dwordx16 s[48:63], s[0:1], 0
    s_load_dwordx4 s[64:67], s[0:1], 64
    s_memrealtime s[34:35]
    v_and_b32 v143, 63, v0
    v_lshrrev_b32 v1, 6, v0
    s_nop 0
    v_readfirstlane_b32 s20, v1
    s_and_b32 s36, s2, 7
    s_lshr_b32 s37, s2, 3
    s_lshr_b32 s23, s36, 1
    s_lshl_b32 s23, s23, 2
    s_lshr_b32 s38, s37, 3
    s_add_u32 s23, s23, s38
    s_and_b32 s24, s36, 1
    s_lshl_b32 s24, s24, 3
    s_and_b32 s38, s37, 7
    s_add_u32 s24, s24, s38
    s_and_b32 s68, s36, 3
    s_lshl_b32 s68, s68, 2
    s_and_b32 s38, s37, 3
    s_add_u32 s68, s68, s38
    s_lshr_b32 s69, s36, 2
    s_lshl_b32 s69, s69, 3
    s_lshr_b32 s38, s37, 2
    s_add_u32 s69, s69, s38
    v_lshlrev_b32 v142, 4, v143
    s_mov_b32 s6, 0x400000
    s_mov_b32 s7, 0x20000
    s_mov_b32 s10, 0x600000
    s_mov_b32 s11, 0x20000
    s_mov_b32 s14, 35651584
    s_mov_b32 s15, 0x20000
    s_mov_b32 s19, 0x20000
    s_cmp_lt_u32 s20, 4
    s_cbranch_scc1 L_C
    s_sub_u32 s21, s20, 4
    s_and_b32 s92, s36, 1
    s_lshl_b32 s92, s92, 3
    s_lshr_b32 s38, s36, 1
    s_lshl_b32 s38, s38, 2
    s_add_u32 s92, s92, s38
    v_lshrrev_b32 v16, 3, v143
    v_lshlrev_b32 v16, 11, v16
    v_lshrrev_b32 v17, 4, v143
    v_and_b32 v18, 7, v143
    v_lshl_add_u32 v9, v18, 4, v16
    v_xor_b32 v17, v17, v18
    v_lshl_add_u32 v2, v17, 4, v16
    v_xor_b32 v17, 4, v17
    v_lshl_add_u32 v3, v17, 4, v16
    v_add_u32 v3, 15360, v3
    v_add_u32 v4, 30720, v2
    v_add_u32 v5, 30720, v3
    s_lshl_b32 s40, s21, 12
    s_lshl_b32 s27, s24, 18
    s_lshl_b32 s38, s21, 16
    s_add_u32 s27, s27, s38
    s_waitcnt lgkmcnt(0)
    s_mov_b32 s4, s48
    s_mov_b32 s5, s49
    s_add_u32 s99, s92, 0
    s_and_b32 s99, s99, 15
    s_lshl_b32 s99, s99, 7
    s_add_u32 m0, s40, 0
    s_add_u32 s43, s27, s99
    buffer_load_dwordx4 v2, s[4:7], s43 offen offset:0 sc1 lds
    buffer_load_dwordx4 v3, s[4:7], s43 offen offset:1024 sc1 lds
    buffer_load_dwordx4 v4, s[4:7], s43 offen offset:2048 sc1 lds
    buffer_load_dwordx4 v5, s[4:7], s43 offen offset:3072 sc1 lds
    v_add_u32 v16, 0, v143
    v_mul_u32_u24 v17, 2731, v16
    v_lshrrev_b32 v17, 16, v17
    v_mul_u32_u24 v18, 24, v17
    v_sub_u32 v18, v16, v18
    v_lshrrev_b32 v19, 2, v18
    v_bfe_u32 v20, v17, 1, 1
    v_xor_b32 v19, v19, v20
    v_mul_u32_u24 v16, 6144, v17
    v_lshrrev_b32 v20, 1, v19
    v_lshl_add_u32 v16, v20, 11, v16
    v_mul_u32_u24 v20, 5, v20
    v_add_u32 v20, s23, v20
    v_and_b32 v20, 15, v20
    v_lshl_add_u32 v16, v20, 7, v16
    v_and_b32 v20, 1, v19
    v_lshl_add_u32 v16, v20, 6, v16
    v_and_b32 v20, 3, v18
    v_lshl_add_u32 v16, v20, 4, v16
    v_subrev_u32 v6, 0, v16
    v_xor_b32 v136, 32, v6
    v_add_u32 v16, 64, v143
    v_mul_u32_u24 v17, 2731, v16
    v_lshrrev_b32 v17, 16, v17
    v_mul_u32_u24 v18, 24, v17
    v_sub_u32 v18, v16, v18
    v_lshrrev_b32 v19, 2, v18
    v_bfe_u32 v20, v17, 1, 1
    v_xor_b32 v19, v19, v20
    v_mul_u32_u24 v16, 6144, v17
    v_lshrrev_b32 v20, 1, v19
    v_lshl_add_u32 v16, v20, 11, v16
    v_mul_u32_u24 v20, 5, v20
    v_add_u32 v20, s23, v20
    v_and_b32 v20, 15, v20
    v_lshl_add_u32 v16, v20, 7, v16
    v_and_b32 v20, 1, v19
    v_lshl_add_u32 v16, v20, 6, v16
    v_and_b32 v20, 3, v18
    v_lshl_add_u32 v16, v20, 4, v16
    v_subrev_u32 v7, 1024, v16
    v_xor_b32 v137, 32, v7
    v_add_u32 v16, 128, v143
    v_mul_u32_u24 v17, 2731, v16
    v_lshrrev_b32 v17, 16, v17
    v_mul_u32_u24 v18, 24, v17
    v_sub_u32 v18, v16, v18
    v_lshrrev_b32 v19, 2, v18
    v_bfe_u32 v20, v17, 1, 1
    v_xor_b32 v19, v19, v20
    v_mul_u32_u24 v16, 6144, v17
    v_lshrrev_b32 v20, 1, v19
    v_lshl_add_u32 v16, v20, 11, v16
    v_mul_u32_u24 v20, 5, v20
    v_add_u32 v20, s23, v20
    v_and_b32 v20, 15, v20
    v_lshl_add_u32 v16, v20, 7, v16
    v_and_b32 v20, 1, v19
    v_lshl_add_u32 v16, v20, 6, v16
    v_and_b32 v20, 3, v18
    v_lshl_add_u32 v16, v20, 4, v16
    v_subrev_u32 v8, 2048, v16
    v_xor_b32 v138, 32, v8
    s_mul_i32 s28, s21, 98304
    s_mul_i32 s41, s21, 6144
    s_add_u32 s41, s41, 16384
    s_lshl_b32 s46, s2, 2
    s_add_u32 s46, s46, s21
    s_mov_b32 s8, s50
    s_mov_b32 s9, s51
    s_mov_b32 s12, s66
    s_mov_b32 s13, s67
    s_add_u32 s99, s92, 0
    s_and_b32 s99, s99, 15
    s_mul_i32 s100, s99, 393216
    s_add_u32 s100, s100, s28
    s_add_u32 m0, s41, 0
    s_add_u32 s43, s100, 0
    buffer_load_dwordx4 v6, s[8:11], s43 offen offset:0 sc1 lds
    buffer_load_dwordx4 v7, s[8:11], s43 offen offset:1024 sc1 lds
    buffer_load_dwordx4 v8, s[8:11], s43 offen offset:2048 sc1 lds
    s_add_u32 m0, s41, 3072
    s_add_u32 s43, s100, 49152
    buffer_load_dwordx4 v136, s[8:11], s43 offen offset:0 sc1 lds
    buffer_load_dwordx4 v137, s[8:11], s43 offen offset:1024 sc1 lds
    buffer_load_dwordx4 v138, s[8:11], s43 offen offset:2048 sc1 lds
    s_mov_b32 s16, s64
    s_mov_b32 s17, s65
    s_mov_b32 s18, 256
    s_cmp_lg_u32 s46, 0
    s_cbranch_scc1 L_notag
    s_or_b32 s34, s34, 1
    v_mov_b32 v14, s34
    v_mov_b32 v15, 0
    buffer_store_dword v14, v15, s[16:19], 0 offen sc1
L_notag:
    s_add_u32 s99, s92, 1
    s_and_b32 s99, s99, 15
    s_lshl_b32 s99, s99, 7
    s_add_u32 m0, s40, 40960
    s_add_u32 s43, s27, s99
    buffer_load_dwordx4 v2, s[4:7], s43 offen offset:0 sc1 lds
    buffer_load_dwordx4 v3, s[4:7], s43 offen offset:1024 sc1 lds
    buffer_load_dwordx4 v4, s[4:7], s43 offen offset:2048 sc1 lds
    buffer_load_dwordx4 v5, s[4:7], s43 offen offset:3072 sc1 lds
    s_add_u32 s99, s92, 1
    s_and_b32 s99, s99, 15
    s_mul_i32 s100, s99, 393216
    s_add_u32 s100, s100, s28
    s_add_u32 m0, s41, 40960
    s_add_u32 s43, s100, 0
    buffer_load_dwordx4 v6, s[8:11], s43 offen offset:0 sc1 lds
    buffer_load_dwordx4 v7, s[8:11], s43 offen offset:1024 sc1 lds
    buffer_load_dwordx4 v8, s[8:11], s43 offen offset:2048 sc1 lds
    s_add_u32 m0, s41, 44032
    s_add_u32 s43, s100, 49152
    buffer_load_dwordx4 v136, s[8:11], s43 offen offset:0 sc1 lds
    buffer_load_dwordx4 v137, s[8:11], s43 offen offset:1024 sc1 lds
    buffer_load_dwordx4 v138, s[8:11], s43 offen offset:2048 sc1 lds
    s_add_u32 s99, s92, 2
    s_and_b32 s99, s99, 15
    s_lshl_b32 s99, s99, 7
    s_add_u32 m0, s40, 81920
    s_add_u32 s43, s27, s99
    buffer_load_dwordx4 v2, s[4:7], s43 offen offset:0 sc1 lds
    buffer_load_dwordx4 v3, s[4:7], s43 offen offset:1024 sc1 lds
    buffer_load_dwordx4 v4, s[4:7], s43 offen offset:2048 sc1 lds
    buffer_load_dwordx4 v5, s[4:7], s43 offen offset:3072 sc1 lds
    s_add_u32 s99, s92, 2
    s_and_b32 s99, s99, 15
    s_mul_i32 s100, s99, 393216
    s_add_u32 s100, s100, s28
    s_add_u32 m0, s41, 81920
    s_add_u32 s43, s100, 0
    buffer_load_dwordx4 v6, s[8:11], s43 offen offset:0 sc1 lds
    buffer_load_dwordx4 v7, s[8:11], s43 offen offset:1024 sc1 lds
    buffer_load_dwordx4 v8, s[8:11], s43 offen offset:2048 sc1 lds
    s_add_u32 m0, s41, 84992
    s_add_u32 s43, s100, 49152
    buffer_load_dwordx4 v136, s[8:11], s43 offen offset:0 sc1 lds
    buffer_load_dwordx4 v137, s[8:11], s43 offen offset:1024 sc1 lds
    buffer_load_dwordx4 v138, s[8:11], s43 offen offset:2048 sc1 lds
    s_lshl_b32 s39, s46, 10
    s_mov_b32 s16, s50
    s_mov_b32 s17, s51
    s_mov_b32 s18, 0x600000
    s_and_b32 s37, s46, 255
    s_lshl_b32 s37, s37, 14
    s_lshr_b32 s38, s46, 8
    s_lshl_b32 s38, s38, 7
    s_add_u32 s37, s37, s38
    s_waitcnt vmcnt(20)
    s_barrier
    s_mul_i32 s25, s46, 6144
    s_lshl_b32 s26, s46, 11
    s_add_u32 s99, s92, 3
    s_and_b32 s99, s99, 15
    s_lshl_b32 s99, s99, 7
    s_add_u32 m0, s40, 122880
    s_add_u32 s43, s27, s99
    buffer_load_dwordx4 v2, s[4:7], s43 offen offset:0 sc1 lds
    buffer_load_dwordx4 v3, s[4:7], s43 offen offset:1024 sc1 lds
    buffer_load_dwordx4 v4, s[4:7], s43 offen offset:2048 sc1 lds
    buffer_load_dwordx4 v5, s[4:7], s43 offen offset:3072 sc1 lds
    s_load_dwordx2 s[30:31], s[56:57], s25 offset:0x3c
    s_load_dwordx2 s[30:31], s[56:57], s25 offset:0xbc
    s_load_dwordx2 s[30:31], s[56:57], s25 offset:0x13c
    s_load_dwordx2 s[30:31], s[56:57], s25 offset:0x1bc
    s_waitcnt vmcnt(14)
    s_barrier
    s_add_u32 s99, s92, 3
    s_and_b32 s99, s99, 15
    s_mul_i32 s100, s99, 393216
    s_add_u32 s100, s100, s28
    s_add_u32 m0, s41, 122880
    s_add_u32 s43, s100, 0
    buffer_load_dwordx4 v6, s[8:11], s43 offen offset:0 sc1 lds
    buffer_load_dwordx4 v7, s[8:11], s43 offen offset:1024 sc1 lds
    buffer_load_dwordx4 v8, s[8:11], s43 offen offset:2048 sc1 lds
    s_add_u32 m0, s41, 125952
    s_add_u32 s43, s100, 49152
    buffer_load_dwordx4 v136, s[8:11], s43 offen offset:0 sc1 lds
    buffer_load_dwordx4 v137, s[8:11], s43 offen offset:1024 sc1 lds
    buffer_load_dwordx4 v138, s[8:11], s43 offen offset:2048 sc1 lds
    s_add_u32 s99, s92, 4
    s_and_b32 s99, s99, 15
    s_lshl_b32 s99, s99, 7
    s_add_u32 m0, s40, 0
    s_add_u32 s43, s27, s99
    buffer_load_dwordx4 v2, s[4:7], s43 offen offset:0 sc1 lds
    buffer_load_dwordx4 v3, s[4:7], s43 offen offset:1024 sc1 lds
    buffer_load_dwordx4 v4, s[4:7], s43 offen offset:2048 sc1 lds
    buffer_load_dwordx4 v5, s[4:7], s43 offen offset:3072 sc1 lds
    s_load_dwordx2 s[30:31], s[56:57], s25 offset:0x23c
    s_load_dwordx2 s[30:31], s[56:57], s25 offset:0x2bc
    s_load_dwordx2 s[30:31], s[56:57], s25 offset:0x33c
    s_load_dwordx2 s[30:31], s[56:57], s25 offset:0x3bc
    s_waitcnt vmcnt(14)
    s_barrier
    s_add_u32 s99, s92, 4
    s_and_b32 s99, s99, 15
    s_mul_i32 s100, s99, 393216
    s_add_u32 s100, s100, s28
    s_add_u32 m0, s41, 0
    s_add_u32 s43, s100, 0
    buffer_load_dwordx4 v6, s[8:11], s43 offen offset:0 sc1 lds
    buffer_load_dwordx4 v7, s[8:11], s43 offen offset:1024 sc1 lds
    buffer_load_dwordx4 v8, s[8:11], s43 offen offset:2048 sc1 lds
    s_add_u32 m0, s41, 3072
    s_add_u32 s43, s100, 49152
    buffer_load_dwordx4 v136, s[8:11], s43 offen offset:0 sc1 lds
    buffer_load_dwordx4 v137, s[8:11], s43 offen offset:1024 sc1 lds
    buffer_load_dwordx4 v138, s[8:11], s43 offen offset:2048 sc1 lds
    s_add_u32 s99, s92, 5
    s_and_b32 s99, s99, 15
    s_lshl_b32 s99, s99, 7
    s_add_u32 m0, s40, 40960
    s_add_u32 s43, s27, s99
    buffer_load_dwordx4 v2, s[4:7], s43 offen offset:0 sc1 lds
    buffer_load_dwordx4 v3, s[4:7], s43 offen offset:1024 sc1 lds
    buffer_load_dwordx4 v4, s[4:7], s43 offen offset:2048 sc1 lds
    buffer_load_dwordx4 v5, s[4:7], s43 offen offset:3072 sc1 lds
    s_load_dwordx2 s[30:31], s[56:57], s25 offset:0x43c
    s_load_dwordx2 s[30:31], s[56:57], s25 offset:0x4bc
    s_load_dwordx2 s[30:31], s[56:57], s25 offset:0x53c
    s_load_dwordx2 s[30:31], s[56:57], s25 offset:0x5bc
    s_waitcnt vmcnt(14)
    s_barrier
    s_add_u32 s99, s92, 5
    s_and_b32 s99, s99, 15
    s_mul_i32 s100, s99, 393216
    s_add_u32 s100, s100, s28
    s_add_u32 m0, s41, 40960
    s_add_u32 s43, s100, 0
    buffer_load_dwordx4 v6, s[8:11], s43 offen offset:0 sc1 lds
    buffer_load_dwordx4 v7, s[8:11], s43 offen offset:1024 sc1 lds
    buffer_load_dwordx4 v8, s[8:11], s43 offen offset:2048 sc1 lds
    s_add_u32 m0, s41, 44032
    s_add_u32 s43, s100, 49152
    buffer_load_dwordx4 v136, s[8:11], s43 offen offset:0 sc1 lds
    buffer_load_dwordx4 v137, s[8:11], s43 offen offset:1024 sc1 lds
    buffer_load_dwordx4 v138, s[8:11], s43 offen offset:2048 sc1 lds
    s_add_u32 s99, s92, 6
    s_and_b32 s99, s99, 15
    s_lshl_b32 s99, s99, 7
    s_add_u32 m0, s40, 81920
    s_add_u32 s43, s27, s99
    buffer_load_dwordx4 v2, s[4:7], s43 offen offset:0 sc1 lds
    buffer_load_dwordx4 v3, s[4:7], s43 offen offset:1024 sc1 lds
    buffer_load_dwordx4 v4, s[4:7], s43 offen offset:2048 sc1 lds
    buffer_load_dwordx4 v5, s[4:7], s43 offen offset:3072 sc1 lds
    s_load_dwordx2 s[30:31], s[56:57], s25 offset:0x63c
    s_load_dwordx2 s[30:31], s[56:57], s25 offset:0x6bc
    s_load_dwordx2 s[30:31], s[56:57], s25 offset:0x73c
    s_load_dwordx2 s[30:31], s[56:57], s25 offset:0x7bc
    s_waitcnt vmcnt(14)
    s_barrier
    s_add_u32 s99, s92, 6
    s_and_b32 s99, s99, 15
    s_mul_i32 s100, s99, 393216
    s_add_u32 s100, s100, s28
    s_add_u32 m0, s41, 81920
    s_add_u32 s43, s100, 0
    buffer_load_dwordx4 v6, s[8:11], s43 offen offset:0 sc1 lds
    buffer_load_dwordx4 v7, s[8:11], s43 offen offset:1024 sc1 lds
    buffer_load_dwordx4 v8, s[8:11], s43 offen offset:2048 sc1 lds
    s_add_u32 m0, s41, 84992
    s_add_u32 s43, s100, 49152
    buffer_load_dwordx4 v136, s[8:11], s43 offen offset:0 sc1 lds
    buffer_load_dwordx4 v137, s[8:11], s43 offen offset:1024 sc1 lds
    buffer_load_dwordx4 v138, s[8:11], s43 offen offset:2048 sc1 lds
    s_add_u32 s99, s92, 7
    s_and_b32 s99, s99, 15
    s_lshl_b32 s99, s99, 7
    s_add_u32 m0, s40, 122880
    s_add_u32 s43, s27, s99
    buffer_load_dwordx4 v2, s[4:7], s43 offen offset:0 sc1 lds
    buffer_load_dwordx4 v3, s[4:7], s43 offen offset:1024 sc1 lds
    buffer_load_dwordx4 v4, s[4:7], s43 offen offset:2048 sc1 lds
    buffer_load_dwordx4 v5, s[4:7], s43 offen offset:3072 sc1 lds
    s_load_dwordx2 s[30:31], s[56:57], s25 offset:0x83c
    s_load_dwordx2 s[30:31], s[56:57], s25 offset:0x8bc
    s_load_dwordx2 s[30:31], s[56:57], s25 offset:0x93c
    s_load_dwordx2 s[30:31], s[56:57], s25 offset:0x9bc
    s_waitcnt vmcnt(14)
    s_barrier
    s_add_u32 s99, s92, 7
    s_and_b32 s99, s99, 15
    s_mul_i32 s100, s99, 393216
    s_add_u32 s100, s100, s28
    s_add_u32 m0, s41, 122880
    s_add_u32 s43, s100, 0
    buffer_load_dwordx4 v6, s[8:11], s43 offen offset:0 sc1 lds
    buffer_load_dwordx4 v7, s[8:11], s43 offen offset:1024 sc1 lds
    buffer_load_dwordx4 v8, s[8:11], s43 offen offset:2048 sc1 lds
    s_add_u32 m0, s41, 125952
    s_add_u32 s43, s100, 49152
    buffer_load_dwordx4 v136, s[8:11], s43 offen offset:0 sc1 lds
    buffer_load_dwordx4 v137, s[8:11], s43 offen offset:1024 sc1 lds
    buffer_load_dwordx4 v138, s[8:11], s43 offen offset:2048 sc1 lds
    s_add_u32 s99, s92, 8
    s_and_b32 s99, s99, 15
    s_lshl_b32 s99, s99, 7
    s_add_u32 m0, s40, 0
    s_add_u32 s43, s27, s99
    buffer_load_dwordx4 v2, s[4:7], s43 offen offset:0 sc1 lds
    buffer_load_dwordx4 v3, s[4:7], s43 offen offset:1024 sc1 lds
    buffer_load_dwordx4 v4, s[4:7], s43 offen offset:2048 sc1 lds
    buffer_load_dwordx4 v5, s[4:7], s43 offen offset:3072 sc1 lds
    s_load_dwordx2 s[30:31], s[56:57], s25 offset:0xa3c
    s_load_dwordx2 s[30:31], s[56:57], s25 offset:0xabc
    s_load_dwordx2 s[30:31], s[56:57], s25 offset:0xb3c
    s_load_dwordx2 s[30:31], s[56:57], s25 offset:0xbbc
    s_waitcnt vmcnt(14)
    s_barrier
    s_add_u32 s99, s92, 8
    s_and_b32 s99, s99, 15
    s_mul_i32 s100, s99, 393216
    s_add_u32 s100, s100, s28
    s_add_u32 m0, s41, 0
    s_add_u32 s43, s100, 0
    buffer_load_dwordx4 v6, s[8:11], s43 offen offset:0 sc1 lds
    buffer_load_dwordx4 v7, s[8:11], s43 offen offset:1024 sc1 lds
    buffer_load_dwordx4 v8, s[8:11], s43 offen offset:2048 sc1 lds
    s_add_u32 m0, s41, 3072
    s_add_u32 s43, s100, 49152
    buffer_load_dwordx4 v136, s[8:11], s43 offen offset:0 sc1 lds
    buffer_load_dwordx4 v137, s[8:11], s43 offen offset:1024 sc1 lds
    buffer_load_dwordx4 v138, s[8:11], s43 offen offset:2048 sc1 lds
    s_add_u32 s99, s92, 9
    s_and_b32 s99, s99, 15
    s_lshl_b32 s99, s99, 7
    s_add_u32 m0, s40, 40960
    s_add_u32 s43, s27, s99
    buffer_load_dwordx4 v2, s[4:7], s43 offen offset:0 sc1 lds
    buffer_load_dwordx4 v3, s[4:7], s43 offen offset:1024 sc1 lds
    buffer_load_dwordx4 v4, s[4:7], s43 offen offset:2048 sc1 lds
    buffer_load_dwordx4 v5, s[4:7], s43 offen offset:3072 sc1 lds
    s_load_dwordx2 s[30:31], s[56:57], s25 offset:0xc3c
    s_load_dwordx2 s[30:31], s[56:57], s25 offset:0xcbc
    s_load_dwordx2 s[30:31], s[56:57], s25 offset:0xd3c
    s_load_dwordx2 s[30:31], s[56:57], s25 offset:0xdbc
    s_waitcnt vmcnt(14)
    s_barrier
    s_add_u32 s99, s92, 9
    s_and_b32 s99, s99, 15
    s_mul_i32 s100, s99, 393216
    s_add_u32 s100, s100, s28
    s_add_u32 m0, s41, 40960
    s_add_u32 s43, s100, 0
    buffer_load_dwordx4 v6, s[8:11], s43 offen offset:0 sc1 lds
    buffer_load_dwordx4 v7, s[8:11], s43 offen offset:1024 sc1 lds
    buffer_load_dwordx4 v8, s[8:11], s43 offen offset:2048 sc1 lds
    s_add_u32 m0, s41, 44032
    s_add_u32 s43, s100, 49152
    buffer_load_dwordx4 v136, s[8:11], s43 offen offset:0 sc1 lds
    buffer_load_dwordx4 v137, s[8:11], s43 offen offset:1024 sc1 lds
    buffer_load_dwordx4 v138, s[8:11], s43 offen offset:2048 sc1 lds
    s_add_u32 s99, s92, 10
    s_and_b32 s99, s99, 15
    s_lshl_b32 s99, s99, 7
    s_add_u32 m0, s40, 81920
    s_add_u32 s43, s27, s99
    buffer_load_dwordx4 v2, s[4:7], s43 offen offset:0 sc1 lds
    buffer_load_dwordx4 v3, s[4:7], s43 offen offset:1024 sc1 lds
    buffer_load_dwordx4 v4, s[4:7], s43 offen offset:2048 sc1 lds
    buffer_load_dwordx4 v5, s[4:7], s43 offen offset:3072 sc1 lds
    s_load_dwordx2 s[30:31], s[56:57], s25 offset:0xe3c
    s_load_dwordx2 s[30:31], s[56:57], s25 offset:0xebc
    s_load_dwordx2 s[30:31], s[56:57], s25 offset:0xf3c
    s_load_dwordx2 s[30:31], s[56:57], s25 offset:0xfbc
    s_waitcnt vmcnt(14)
    s_barrier
    s_add_u32 s99, s92, 10
    s_and_b32 s99, s99, 15
    s_mul_i32 s100, s99, 393216
    s_add_u32 s100, s100, s28
    s_add_u32 m0, s41, 81920
    s_add_u32 s43, s100, 0
    buffer_load_dwordx4 v6, s[8:11], s43 offen offset:0 sc1 lds
    buffer_load_dwordx4 v7, s[8:11], s43 offen offset:1024 sc1 lds
    buffer_load_dwordx4 v8, s[8:11], s43 offen offset:2048 sc1 lds
    s_add_u32 m0, s41, 84992
    s_add_u32 s43, s100, 49152
    buffer_load_dwordx4 v136, s[8:11], s43 offen offset:0 sc1 lds
    buffer_load_dwordx4 v137, s[8:11], s43 offen offset:1024 sc1 lds
    buffer_load_dwordx4 v138, s[8:11], s43 offen offset:2048 sc1 lds
    s_add_u32 s99, s92, 11
    s_and_b32 s99, s99, 15
    s_lshl_b32 s99, s99, 7
    s_add_u32 m0, s40, 122880
    s_add_u32 s43, s27, s99
    buffer_load_dwordx4 v2, s[4:7], s43 offen offset:0 sc1 lds
    buffer_load_dwordx4 v3, s[4:7], s43 offen offset:1024 sc1 lds
    buffer_load_dwordx4 v4, s[4:7], s43 offen offset:2048 sc1 lds
    buffer_load_dwordx4 v5, s[4:7], s43 offen offset:3072 sc1 lds
    s_load_dwordx2 s[30:31], s[56:57], s25 offset:0x103c
    s_load_dwordx2 s[30:31], s[56:57], s25 offset:0x10bc
    s_load_dwordx2 s[30:31], s[56:57], s25 offset:0x113c
    s_load_dwordx2 s[30:31], s[56:57], s25 offset:0x11bc
    s_waitcnt vmcnt(14)
    s_barrier
    s_add_u32 s99, s92, 11
    s_and_b32 s99, s99, 15
    s_mul_i32 s100, s99, 393216
    s_add_u32 s100, s100, s28
    s_add_u32 m0, s41, 122880
    s_add_u32 s43, s100, 0
    buffer_load_dwordx4 v6, s[8:11], s43 offen offset:0 sc1 lds
    buffer_load_dwordx4 v7, s[8:11], s43 offen offset:1024 sc1 lds
    buffer_load_dwordx4 v8, s[8:11], s43 offen offset:2048 sc1 lds
    s_add_u32 m0, s41, 125952
    s_add_u32 s43, s100, 49152
    buffer_load_dwordx4 v136, s[8:11], s43 offen offset:0 sc1 lds
    buffer_load_dwordx4 v137, s[8:11], s43 offen offset:1024 sc1 lds
    buffer_load_dwordx4 v138, s[8:11], s43 offen offset:2048 sc1 lds
    s_add_u32 s99, s92, 12
    s_and_b32 s99, s99, 15
    s_lshl_b32 s99, s99, 7
    s_add_u32 m0, s40, 0
    s_add_u32 s43, s27, s99
    buffer_load_dwordx4 v2, s[4:7], s43 offen offset:0 sc1 lds
    buffer_load_dwordx4 v3, s[4:7], s43 offen offset:1024 sc1 lds
    buffer_load_dwordx4 v4, s[4:7], s43 offen offset:2048 sc1 lds
    buffer_load_dwordx4 v5, s[4:7], s43 offen offset:3072 sc1 lds
    s_load_dwordx2 s[30:31], s[56:57], s25 offset:0x123c
    s_load_dwordx2 s[30:31], s[56:57], s25 offset:0x12bc
    s_load_dwordx2 s[30:31], s[56:57], s25 offset:0x133c
    s_load_dwordx2 s[30:31], s[56:57], s25 offset:0x13bc
    s_waitcnt vmcnt(14)
    s_barrier
    s_add_u32 s99, s92, 12
    s_and_b32 s99, s99, 15
    s_mul_i32 s100, s99, 393216
    s_add_u32 s100, s100, s28
    s_add_u32 m0, s41, 0
    s_add_u32 s43, s100, 0
    buffer_load_dwordx4 v6, s[8:11], s43 offen offset:0 sc1 lds
    buffer_load_dwordx4 v7, s[8:11], s43 offen offset:1024 sc1 lds
    buffer_load_dwordx4 v8, s[8:11], s43 offen offset:2048 sc1 lds
    s_add_u32 m0, s41, 3072
    s_add_u32 s43, s100, 49152
    buffer_load_dwordx4 v136, s[8:11], s43 offen offset:0 sc1 lds
    buffer_load_dwordx4 v137, s[8:11], s43 offen offset:1024 sc1 lds
    buffer_load_dwordx4 v138, s[8:11], s43 offen offset:2048 sc1 lds
    s_add_u32 s99, s92, 13
    s_and_b32 s99, s99, 15
    s_lshl_b32 s99, s99, 7
    s_add_u32 m0, s40, 40960
    s_add_u32 s43, s27, s99
    buffer_load_dwordx4 v2, s[4:7], s43 offen offset:0 sc1 lds
    buffer_load_dwordx4 v3, s[4:7], s43 offen offset:1024 sc1 lds
    buffer_load_dwordx4 v4, s[4:7], s43 offen offset:2048 sc1 lds
    buffer_load_dwordx4 v5, s[4:7], s43 offen offset:3072 sc1 lds
    s_load_dwordx2 s[30:31], s[56:57], s25 offset:0x143c
    s_load_dwordx2 s[30:31], s[56:57], s25 offset:0x14bc
    s_load_dwordx2 s[30:31], s[56:57], s25 offset:0x153c
    s_load_dwordx2 s[30:31], s[56:57], s25 offset:0x15bc
    s_waitcnt vmcnt(14)
    s_barrier
    s_add_u32 s99, s92, 13
    s_and_b32 s99, s99, 15
    s_mul_i32 s100, s99, 393216
    s_add_u32 s100, s100, s28
    s_add_u32 m0, s41, 40960
    s_add_u32 s43, s100, 0
    buffer_load_dwordx4 v6, s[8:11], s43 offen offset:0 sc1 lds
    buffer_load_dwordx4 v7, s[8:11], s43 offen offset:1024 sc1 lds
    buffer_load_dwordx4 v8, s[8:11], s43 offen offset:2048 sc1 lds
    s_add_u32 m0, s41, 44032
    s_add_u32 s43, s100, 49152
    buffer_load_dwordx4 v136, s[8:11], s43 offen offset:0 sc1 lds
    buffer_load_dwordx4 v137, s[8:11], s43 offen offset:1024 sc1 lds
    buffer_load_dwordx4 v138, s[8:11], s43 offen offset:2048 sc1 lds
    s_add_u32 s99, s92, 14
    s_and_b32 s99, s99, 15
    s_lshl_b32 s99, s99, 7
    s_add_u32 m0, s40, 81920
    s_add_u32 s43, s27, s99
    buffer_load_dwordx4 v2, s[4:7], s43 offen offset:0 sc1 lds
    buffer_load_dwordx4 v3, s[4:7], s43 offen offset:1024 sc1 lds
    buffer_load_dwordx4 v4, s[4:7], s43 offen offset:2048 sc1 lds
    buffer_load_dwordx4 v5, s[4:7], s43 offen offset:3072 sc1 lds
    s_load_dwordx2 s[30:31], s[56:57], s25 offset:0x163c
    s_load_dwordx2 s[30:31], s[56:57], s25 offset:0x16bc
    s_load_dwordx2 s[30:31], s[56:57], s25 offset:0x173c
    s_load_dwordx2 s[30:31], s[56:57], s25 offset:0x17bc
    s_waitcnt vmcnt(14)
    s_barrier
    s_add_u32 s99, s92, 14
    s_and_b32 s99, s99, 15
    s_mul_i32 s100, s99, 393216
    s_add_u32 s100, s100, s28
    s_add_u32 m0, s41, 81920
    s_add_u32 s43, s100, 0
    buffer_load_dwordx4 v6, s[8:11], s43 offen offset:0 sc1 lds
    buffer_load_dwordx4 v7, s[8:11], s43 offen offset:1024 sc1 lds
    buffer_load_dwordx4 v8, s[8:11], s43 offen offset:2048 sc1 lds
    s_add_u32 m0, s41, 84992
    s_add_u32 s43, s100, 49152
    buffer_load_dwordx4 v136, s[8:11], s43 offen offset:0 sc1 lds
    buffer_load_dwordx4 v137, s[8:11], s43 offen offset:1024 sc1 lds
    buffer_load_dwordx4 v138, s[8:11], s43 offen offset:2048 sc1 lds
    s_add_u32 s99, s92, 15
    s_and_b32 s99, s99, 15
    s_lshl_b32 s99, s99, 7
    s_add_u32 m0, s40, 122880
    s_add_u32 s43, s27, s99
    buffer_load_dwordx4 v2, s[4:7], s43 offen offset:0 sc1 lds
    buffer_load_dwordx4 v3, s[4:7], s43 offen offset:1024 sc1 lds
    buffer_load_dwordx4 v4, s[4:7], s43 offen offset:2048 sc1 lds
    buffer_load_dwordx4 v5, s[4:7], s43 offen offset:3072 sc1 lds
    s_load_dwordx2 s[30:31], s[52:53], s26 offset:0x3c
    s_load_dwordx2 s[30:31], s[52:53], s26 offset:0xbc
    s_waitcnt vmcnt(14)
    s_barrier
    s_add_u32 s99, s92, 15
    s_and_b32 s99, s99, 15
    s_mul_i32 s100, s99, 393216
    s_add_u32 s100, s100, s28
    s_add_u32 m0, s41, 122880
    s_add_u32 s43, s100, 0
    buffer_load_dwordx4 v6, s[8:11], s43 offen offset:0 sc1 lds
    buffer_load_dwordx4 v7, s[8:11], s43 offen offset:1024 sc1 lds
    buffer_load_dwordx4 v8, s[8:11], s43 offen offset:2048 sc1 lds
    s_add_u32 m0, s41, 125952
    s_add_u32 s43, s100, 49152
    buffer_load_dwordx4 v136, s[8:11], s43 offen offset:0 sc1 lds
    buffer_load_dwordx4 v137, s[8:11], s43 offen offset:1024 sc1 lds
    buffer_load_dwordx4 v138, s[8:11], s43 offen offset:2048 sc1 lds
    s_add_u32 s99, s92, 0
    s_and_b32 s99, s99, 15
    s_lshl_b32 s99, s99, 7
    s_add_u32 m0, s40, 0
    s_add_u32 s43, s27, s99
    buffer_load_dwordx4 v2, s[4:7], s43 offen offset:0 sc1 lds
    buffer_load_dwordx4 v3, s[4:7], s43 offen offset:1024 sc1 lds
    buffer_load_dwordx4 v4, s[4:7], s43 offen offset:2048 sc1 lds
    buffer_load_dwordx4 v5, s[4:7], s43 offen offset:3072 sc1 lds
    s_load_dwordx2 s[30:31], s[52:53], s26 offset:0x13c
    s_load_dwordx2 s[30:31], s[52:53], s26 offset:0x1bc
    s_waitcnt vmcnt(14)
    s_barrier
    s_mov_b32 s8, s56
    s_mov_b32 s9, s57
    s_add_u32 s99, s92, 0
    s_and_b32 s99, s99, 15
    s_mul_i32 s100, s99, 393216
    s_add_u32 s100, s100, s28
    s_add_u32 m0, s41, 0
    s_add_u32 s43, s100, 0
    buffer_load_dwordx4 v6, s[8:11], s43 offen offset:0 sc1 lds
    buffer_load_dwordx4 v7, s[8:11], s43 offen offset:1024 sc1 lds
    buffer_load_dwordx4 v8, s[8:11], s43 offen offset:2048 sc1 lds
    s_add_u32 m0, s41, 3072
    s_add_u32 s43, s100, 49152
    buffer_load_dwordx4 v136, s[8:11], s43 offen offset:0 sc1 lds
    buffer_load_dwordx4 v137, s[8:11], s43 offen offset:1024 sc1 lds
    buffer_load_dwordx4 v138, s[8:11], s43 offen offset:2048 sc1 lds
    s_add_u32 s99, s92, 1
    s_and_b32 s99, s99, 15
    s_lshl_b32 s99, s99, 7
    s_add_u32 m0, s40, 40960
    s_add_u32 s43, s27, s99
    buffer_load_dwordx4 v2, s[4:7], s43 offen offset:0 sc1 lds
    buffer_load_dwordx4 v3, s[4:7], s43 offen offset:1024 sc1 lds
    buffer_load_dwordx4 v4, s[4:7], s43 offen offset:2048 sc1 lds
    buffer_load_dwordx4 v5, s[4:7], s43 offen offset:3072 sc1 lds
    s_load_dwordx2 s[30:31], s[52:53], s26 offset:0x23c
    s_load_dwordx2 s[30:31], s[52:53], s26 offset:0x2bc
    s_waitcnt vmcnt(14)
    s_barrier
    s_add_u32 s99, s92, 1
    s_and_b32 s99, s99, 15
    s_mul_i32 s100, s99, 393216
    s_add_u32 s100, s100, s28
    s_add_u32 m0, s41, 40960
    s_add_u32 s43, s100, 0
    buffer_load_dwordx4 v6, s[8:11], s43 offen offset:0 sc1 lds
    buffer_load_dwordx4 v7, s[8:11], s43 offen offset:1024 sc1 lds
    buffer_load_dwordx4 v8, s[8:11], s43 offen offset:2048 sc1 lds
    s_add_u32 m0, s41, 44032
    s_add_u32 s43, s100, 49152
    buffer_load_dwordx4 v136, s[8:11], s43 offen offset:0 sc1 lds
    buffer_load_dwordx4 v137, s[8:11], s43 offen offset:1024 sc1 lds
    buffer_load_dwordx4 v138, s[8:11], s43 offen offset:2048 sc1 lds
    s_add_u32 s99, s92, 2
    s_and_b32 s99, s99, 15
    s_lshl_b32 s99, s99, 7
    s_add_u32 m0, s40, 81920
    s_add_u32 s43, s27, s99
    buffer_load_dwordx4 v2, s[4:7], s43 offen offset:0 sc1 lds
    buffer_load_dwordx4 v3, s[4:7], s43 offen offset:1024 sc1 lds
    buffer_load_dwordx4 v4, s[4:7], s43 offen offset:2048 sc1 lds
    buffer_load_dwordx4 v5, s[4:7], s43 offen offset:3072 sc1 lds
    s_load_dwordx2 s[30:31], s[52:53], s26 offset:0x33c
    s_load_dwordx2 s[30:31], s[52:53], s26 offset:0x3bc
    s_waitcnt vmcnt(14)
    s_barrier
    s_add_u32 s99, s92, 2
    s_and_b32 s99, s99, 15
    s_mul_i32 s100, s99, 393216
    s_add_u32 s100, s100, s28
    s_add_u32 m0, s41, 81920
    s_add_u32 s43, s100, 0
    buffer_load_dwordx4 v6, s[8:11], s43 offen offset:0 sc1 lds
    buffer_load_dwordx4 v7, s[8:11], s43 offen offset:1024 sc1 lds
    buffer_load_dwordx4 v8, s[8:11], s43 offen offset:2048 sc1 lds
    s_add_u32 m0, s41, 84992
    s_add_u32 s43, s100, 49152
    buffer_load_dwordx4 v136, s[8:11], s43 offen offset:0 sc1 lds
    buffer_load_dwordx4 v137, s[8:11], s43 offen offset:1024 sc1 lds
    buffer_load_dwordx4 v138, s[8:11], s43 offen offset:2048 sc1 lds
    s_add_u32 s99, s92, 3
    s_and_b32 s99, s99, 15
    s_lshl_b32 s99, s99, 7
    s_add_u32 m0, s40, 122880
    s_add_u32 s43, s27, s99
    buffer_load_dwordx4 v2, s[4:7], s43 offen offset:0 sc1 lds
    buffer_load_dwordx4 v3, s[4:7], s43 offen offset:1024 sc1 lds
    buffer_load_dwordx4 v4, s[4:7], s43 offen offset:2048 sc1 lds
    buffer_load_dwordx4 v5, s[4:7], s43 offen offset:3072 sc1 lds
    s_load_dwordx2 s[30:31], s[52:53], s26 offset:0x43c
    s_load_dwordx2 s[30:31], s[52:53], s26 offset:0x4bc
    s_waitcnt vmcnt(14)
    s_barrier
    s_add_u32 s99, s92, 3
    s_and_b32 s99, s99, 15
    s_mul_i32 s100, s99, 393216
    s_add_u32 s100, s100, s28
    s_add_u32 m0, s41, 122880
    s_add_u32 s43, s100, 0
    buffer_load_dwordx4 v6, s[8:11], s43 offen offset:0 sc1 lds
    buffer_load_dwordx4 v7, s[8:11], s43 offen offset:1024 sc1 lds
    buffer_load_dwordx4 v8, s[8:11], s43 offen offset:2048 sc1 lds
    s_add_u32 m0, s41, 125952
    s_add_u32 s43, s100, 49152
    buffer_load_dwordx4 v136, s[8:11], s43 offen offset:0 sc1 lds
    buffer_load_dwordx4 v137, s[8:11], s43 offen offset:1024 sc1 lds
    buffer_load_dwordx4 v138, s[8:11], s43 offen offset:2048 sc1 lds
    s_add_u32 s99, s92, 4
    s_and_b32 s99, s99, 15
    s_lshl_b32 s99, s99, 7
    s_add_u32 m0, s40, 0
    s_add_u32 s43, s27, s99
    buffer_load_dwordx4 v2, s[4:7], s43 offen offset:0 sc1 lds
    buffer_load_dwordx4 v3, s[4:7], s43 offen offset:1024 sc1 lds
    buffer_load_dwordx4 v4, s[4:7], s43 offen offset:2048 sc1 lds
    buffer_load_dwordx4 v5, s[4:7], s43 offen offset:3072 sc1 lds
    s_load_dwordx2 s[30:31], s[52:53], s26 offset:0x53c
    s_load_dwordx2 s[30:31], s[52:53], s26 offset:0x5bc
    s_waitcnt vmcnt(14)
    s_barrier
    s_add_u32 s99, s92, 4
    s_and_b32 s99, s99, 15
    s_mul_i32 s100, s99, 393216
    s_add_u32 s100, s100, s28
    s_add_u32 m0, s41, 0
    s_add_u32 s43, s100, 0
    buffer_load_dwordx4 v6, s[8:11], s43 offen offset:0 sc1 lds
    buffer_load_dwordx4 v7, s[8:11], s43 offen offset:1024 sc1 lds
    buffer_load_dwordx4 v8, s[8:11], s43 offen offset:2048 sc1 lds
    s_add_u32 m0, s41, 3072
    s_add_u32 s43, s100, 49152
    buffer_load_dwordx4 v136, s[8:11], s43 offen offset:0 sc1 lds
    buffer_load_dwordx4 v137, s[8:11], s43 offen offset:1024 sc1 lds
    buffer_load_dwordx4 v138, s[8:11], s43 offen offset:2048 sc1 lds
    s_add_u32 s99, s92, 5
    s_and_b32 s99, s99, 15
    s_lshl_b32 s99, s99, 7
    s_add_u32 m0, s40, 40960
    s_add_u32 s43, s27, s99
    buffer_load_dwordx4 v2, s[4:7], s43 offen offset:0 sc1 lds
    buffer_load_dwordx4 v3, s[4:7], s43 offen offset:1024 sc1 lds
    buffer_load_dwordx4 v4, s[4:7], s43 offen offset:2048 sc1 lds
    buffer_load_dwordx4 v5, s[4:7], s43 offen offset:3072 sc1 lds
    s_load_dwordx2 s[30:31], s[52:53], s26 offset:0x63c
    s_load_dwordx2 s[30:31], s[52:53], s26 offset:0x6bc
    s_waitcnt vmcnt(14)
    s_barrier
    s_add_u32 s99, s92, 5
    s_and_b32 s99, s99, 15
    s_mul_i32 s100, s99, 393216
    s_add_u32 s100, s100, s28
    s_add_u32 m0, s41, 40960
    s_add_u32 s43, s100, 0
    buffer_load_dwordx4 v6, s[8:11], s43 offen offset:0 sc1 lds
    buffer_load_dwordx4 v7, s[8:11], s43 offen offset:1024 sc1 lds
    buffer_load_dwordx4 v8, s[8:11], s43 offen offset:2048 sc1 lds
    s_add_u32 m0, s41, 44032
    s_add_u32 s43, s100, 49152
    buffer_load_dwordx4 v136, s[8:11], s43 offen offset:0 sc1 lds
    buffer_load_dwordx4 v137, s[8:11], s43 offen offset:1024 sc1 lds
    buffer_load_dwordx4 v138, s[8:11], s43 offen offset:2048 sc1 lds
    s_add_u32 s99, s92, 6
    s_and_b32 s99, s99, 15
    s_lshl_b32 s99, s99, 7
    s_add_u32 m0, s40, 81920
    s_add_u32 s43, s27, s99
    buffer_load_dwordx4 v2, s[4:7], s43 offen offset:0 sc1 lds
    buffer_load_dwordx4 v3, s[4:7], s43 offen offset:1024 sc1 lds
    buffer_load_dwordx4 v4, s[4:7], s43 offen offset:2048 sc1 lds
    buffer_load_dwordx4 v5, s[4:7], s43 offen offset:3072 sc1 lds
    s_load_dwordx2 s[30:31], s[52:53], s26 offset:0x73c
    s_load_dwordx2 s[30:31], s[52:53], s26 offset:0x7bc
    s_waitcnt vmcnt(14)
    s_barrier
    s_add_u32 s99, s92, 6
    s_and_b32 s99, s99, 15
    s_mul_i32 s100, s99, 393216
    s_add_u32 s100, s100, s28
    s_add_u32 m0, s41, 81920
    s_add_u32 s43, s100, 0
    buffer_load_dwordx4 v6, s[8:11], s43 offen offset:0 sc1 lds
    buffer_load_dwordx4 v7, s[8:11], s43 offen offset:1024 sc1 lds
    buffer_load_dwordx4 v8, s[8:11], s43 offen offset:2048 sc1 lds
    s_add_u32 m0, s41, 84992
    s_add_u32 s43, s100, 49152
    buffer_load_dwordx4 v136, s[8:11], s43 offen offset:0 sc1 lds
    buffer_load_dwordx4 v137, s[8:11], s43 offen offset:1024 sc1 lds
    buffer_load_dwordx4 v138, s[8:11], s43 offen offset:2048 sc1 lds
    s_add_u32 s99, s92, 7
    s_and_b32 s99, s99, 15
    s_lshl_b32 s99, s99, 7
    s_add_u32 m0, s40, 122880
    s_add_u32 s43, s27, s99
    buffer_load_dwordx4 v2, s[4:7], s43 offen offset:0 sc1 lds
    buffer_load_dwordx4 v3, s[4:7], s43 offen offset:1024 sc1 lds
    buffer_load_dwordx4 v4, s[4:7], s43 offen offset:2048 sc1 lds
    buffer_load_dwordx4 v5, s[4:7], s43 offen offset:3072 sc1 lds
    s_load_dwordx2 s[30:31], s[58:59], s26 offset:0x3c
    s_load_dwordx2 s[30:31], s[58:59], s26 offset:0xbc
    s_waitcnt vmcnt(14)
    s_barrier
    s_add_u32 s99, s92, 7
    s_and_b32 s99, s99, 15
    s_mul_i32 s100, s99, 393216
    s_add_u32 s100, s100, s28
    s_add_u32 m0, s41, 122880
    s_add_u32 s43, s100, 0
    buffer_load_dwordx4 v6, s[8:11], s43 offen offset:0 sc1 lds
    buffer_load_dwordx4 v7, s[8:11], s43 offen offset:1024 sc1 lds
    buffer_load_dwordx4 v8, s[8:11], s43 offen offset:2048 sc1 lds
    s_add_u32 m0, s41, 125952
    s_add_u32 s43, s100, 49152
    buffer_load_dwordx4 v136, s[8:11], s43 offen offset:0 sc1 lds
    buffer_load_dwordx4 v137, s[8:11], s43 offen offset:1024 sc1 lds
    buffer_load_dwordx4 v138, s[8:11], s43 offen offset:2048 sc1 lds
    s_add_u32 s99, s92, 8
    s_and_b32 s99, s99, 15
    s_lshl_b32 s99, s99, 7
    s_add_u32 m0, s40, 0
    s_add_u32 s43, s27, s99
    buffer_load_dwordx4 v2, s[4:7], s43 offen offset:0 sc1 lds
    buffer_load_dwordx4 v3, s[4:7], s43 offen offset:1024 sc1 lds
    buffer_load_dwordx4 v4, s[4:7], s43 offen offset:2048 sc1 lds
    buffer_load_dwordx4 v5, s[4:7], s43 offen offset:3072 sc1 lds
    s_load_dwordx2 s[30:31], s[58:59], s26 offset:0x13c
    s_load_dwordx2 s[30:31], s[58:59], s26 offset:0x1bc
    s_waitcnt vmcnt(14)
    s_barrier
    s_add_u32 s99, s92, 8
    s_and_b32 s99, s99, 15
    s_mul_i32 s100, s99, 393216
    s_add_u32 s100, s100, s28
    s_add_u32 m0, s41, 0
    s_add_u32 s43, s100, 0
    buffer_load_dwordx4 v6, s[8:11], s43 offen offset:0 sc1 lds
    buffer_load_dwordx4 v7, s[8:11], s43 offen offset:1024 sc1 lds
    buffer_load_dwordx4 v8, s[8:11], s43 offen offset:2048 sc1 lds
    s_add_u32 m0, s41, 3072
    s_add_u32 s43, s100, 49152
    buffer_load_dwordx4 v136, s[8:11], s43 offen offset:0 sc1 lds
    buffer_load_dwordx4 v137, s[8:11], s43 offen offset:1024 sc1 lds
    buffer_load_dwordx4 v138, s[8:11], s43 offen offset:2048 sc1 lds
    s_add_u32 s99, s92, 9
    s_and_b32 s99, s99, 15
    s_lshl_b32 s99, s99, 7
    s_add_u32 m0, s40, 40960
    s_add_u32 s43, s27, s99
    buffer_load_dwordx4 v2, s[4:7], s43 offen offset:0 sc1 lds
    buffer_load_dwordx4 v3, s[4:7], s43 offen offset:1024 sc1 lds
    buffer_load_dwordx4 v4, s[4:7], s43 offen offset:2048 sc1 lds
    buffer_load_dwordx4 v5, s[4:7], s43 offen offset:3072 sc1 lds
    s_load_dwordx2 s[30:31], s[58:59], s26 offset:0x23c
    s_load_dwordx2 s[30:31], s[58:59], s26 offset:0x2bc
    s_waitcnt vmcnt(14)
    s_barrier
    s_add_u32 s99, s92, 9
    s_and_b32 s99, s99, 15
    s_mul_i32 s100, s99, 393216
    s_add_u32 s100, s100, s28
    s_add_u32 m0, s41, 40960
    s_add_u32 s43, s100, 0
    buffer_load_dwordx4 v6, s[8:11], s43 offen offset:0 sc1 lds
    buffer_load_dwordx4 v7, s[8:11], s43 offen offset:1024 sc1 lds
    buffer_load_dwordx4 v8, s[8:11], s43 offen offset:2048 sc1 lds
    s_add_u32 m0, s41, 44032
    s_add_u32 s43, s100, 49152
    buffer_load_dwordx4 v136, s[8:11], s43 offen offset:0 sc1 lds
    buffer_load_dwordx4 v137, s[8:11], s43 offen offset:1024 sc1 lds
    buffer_load_dwordx4 v138, s[8:11], s43 offen offset:2048 sc1 lds
    s_add_u32 s99, s92, 10
    s_and_b32 s99, s99, 15
    s_lshl_b32 s99, s99, 7
    s_add_u32 m0, s40, 81920
    s_add_u32 s43, s27, s99
    buffer_load_dwordx4 v2, s[4:7], s43 offen offset:0 sc1 lds
    buffer_load_dwordx4 v3, s[4:7], s43 offen offset:1024 sc1 lds
    buffer_load_dwordx4 v4, s[4:7], s43 offen offset:2048 sc1 lds
    buffer_load_dwordx4 v5, s[4:7], s43 offen offset:3072 sc1 lds
    s_load_dwordx2 s[30:31], s[58:59], s26 offset:0x33c
    s_load_dwordx2 s[30:31], s[58:59], s26 offset:0x3bc
    s_waitcnt vmcnt(14)
    s_barrier
    s_add_u32 s99, s92, 10
    s_and_b32 s99, s99, 15
    s_mul_i32 s100, s99, 393216
    s_add_u32 s100, s100, s28
    s_add_u32 m0, s41, 81920
    s_add_u32 s43, s100, 0
    buffer_load_dwordx4 v6, s[8:11], s43 offen offset:0 sc1 lds
    buffer_load_dwordx4 v7, s[8:11], s43 offen offset:1024 sc1 lds
    buffer_load_dwordx4 v8, s[8:11], s43 offen offset:2048 sc1 lds
    s_add_u32 m0, s41, 84992
    s_add_u32 s43, s100, 49152
    buffer_load_dwordx4 v136, s[8:11], s43 offen offset:0 sc1 lds
    buffer_load_dwordx4 v137, s[8:11], s43 offen offset:1024 sc1 lds
    buffer_load_dwordx4 v138, s[8:11], s43 offen offset:2048 sc1 lds
    s_add_u32 s99, s92, 11
    s_and_b32 s99, s99, 15
    s_lshl_b32 s99, s99, 7
    s_add_u32 m0, s40, 122880
    s_add_u32 s43, s27, s99
    buffer_load_dwordx4 v2, s[4:7], s43 offen offset:0 sc1 lds
    buffer_load_dwordx4 v3, s[4:7], s43 offen offset:1024 sc1 lds
    buffer_load_dwordx4 v4, s[4:7], s43 offen offset:2048 sc1 lds
    buffer_load_dwordx4 v5, s[4:7], s43 offen offset:3072 sc1 lds
    s_load_dwordx2 s[30:31], s[58:59], s26 offset:0x43c
    s_load_dwordx2 s[30:31], s[58:59], s26 offset:0x4bc
    s_waitcnt vmcnt(14)
    s_barrier
    s_add_u32 s99, s92, 11
    s_and_b32 s99, s99, 15
    s_mul_i32 s100, s99, 393216
    s_add_u32 s100, s100, s28
    s_add_u32 m0, s41, 122880
    s_add_u32 s43, s100, 0
    buffer_load_dwordx4 v6, s[8:11], s43 offen offset:0 sc1 lds
    buffer_load_dwordx4 v7, s[8:11], s43 offen offset:1024 sc1 lds
    buffer_load_dwordx4 v8, s[8:11], s43 offen offset:2048 sc1 lds
    s_add_u32 m0, s41, 125952
    s_add_u32 s43, s100, 49152
    buffer_load_dwordx4 v136, s[8:11], s43 offen offset:0 sc1 lds
    buffer_load_dwordx4 v137, s[8:11], s43 offen offset:1024 sc1 lds
    buffer_load_dwordx4 v138, s[8:11], s43 offen offset:2048 sc1 lds
    s_add_u32 s99, s92, 12
    s_and_b32 s99, s99, 15
    s_lshl_b32 s99, s99, 7
    s_add_u32 m0, s40, 0
    s_add_u32 s43, s27, s99
    buffer_load_dwordx4 v2, s[4:7], s43 offen offset:0 sc1 lds
    buffer_load_dwordx4 v3, s[4:7], s43 offen offset:1024 sc1 lds
    buffer_load_dwordx4 v4, s[4:7], s43 offen offset:2048 sc1 lds
    buffer_load_dwordx4 v5, s[4:7], s43 offen offset:3072 sc1 lds
    s_load_dwordx2 s[30:31], s[58:59], s26 offset:0x53c
    s_load_dwordx2 s[30:31], s[58:59], s26 offset:0x5bc
    s_waitcnt vmcnt(14)
    s_barrier
    s_add_u32 s99, s92, 12
    s_and_b32 s99, s99, 15
    s_mul_i32 s100, s99, 393216
    s_add_u32 s100, s100, s28
    s_add_u32 m0, s41, 0
    s_add_u32 s43, s100, 0
    buffer_load_dwordx4 v6, s[8:11], s43 offen offset:0 sc1 lds
    buffer_load_dwordx4 v7, s[8:11], s43 offen offset:1024 sc1 lds
    buffer_load_dwordx4 v8, s[8:11], s43 offen offset:2048 sc1 lds
    s_add_u32 m0, s41, 3072
    s_add_u32 s43, s100, 49152
    buffer_load_dwordx4 v136, s[8:11], s43 offen offset:0 sc1 lds
    buffer_load_dwordx4 v137, s[8:11], s43 offen offset:1024 sc1 lds
    buffer_load_dwordx4 v138, s[8:11], s43 offen offset:2048 sc1 lds
    s_add_u32 s99, s92, 13
    s_and_b32 s99, s99, 15
    s_lshl_b32 s99, s99, 7
    s_add_u32 m0, s40, 40960
    s_add_u32 s43, s27, s99
    buffer_load_dwordx4 v2, s[4:7], s43 offen offset:0 sc1 lds
    buffer_load_dwordx4 v3, s[4:7], s43 offen offset:1024 sc1 lds
    buffer_load_dwordx4 v4, s[4:7], s43 offen offset:2048 sc1 lds
    buffer_load_dwordx4 v5, s[4:7], s43 offen offset:3072 sc1 lds
    s_load_dwordx2 s[30:31], s[58:59], s26 offset:0x63c
    s_load_dwordx2 s[30:31], s[58:59], s26 offset:0x6bc
    s_mov_b32 s16, s64
    s_mov_b32 s17, s65
    s_mov_b32 s18, 256
    v_mov_b32 v140, 0
    s_sub_u32 s36, s23, 5
    s_and_b32 s36, s36, 15
    s_lshl_b32 s36, s36, 8
    s_add_u32 s36, s36, 34603008
    s_sub_u32 s101, s23, 10
    s_and_b32 s101, s101, 15
    s_lshl_b32 s101, s101, 8
    s_add_u32 s101, s101, 34603008
    buffer_load_dword v1, v140, s[16:19], 0 offen sc1
    v_lshrrev_b32 v140, 2, v142
    buffer_load_dword v141, v140, s[12:15], s36 offen sc1
    buffer_load_dword v12, v140, s[12:15], s101 offen sc1
    s_waitcnt vmcnt(17)
    s_barrier
    s_add_u32 s99, s92, 13
    s_and_b32 s99, s99, 15
    s_mul_i32 s100, s99, 393216
    s_add_u32 s100, s100, s28
    s_add_u32 m0, s41, 40960
    s_add_u32 s43, s100, 0
    buffer_load_dwordx4 v6, s[8:11], s43 offen offset:0 sc1 lds
    buffer_load_dwordx4 v7, s[8:11], s43 offen offset:1024 sc1 lds
    buffer_load_dwordx4 v8, s[8:11], s43 offen offset:2048 sc1 lds
    s_add_u32 m0, s41, 44032
    s_add_u32 s43, s100, 49152
    buffer_load_dwordx4 v136, s[8:11], s43 offen offset:0 sc1 lds
    buffer_load_dwordx4 v137, s[8:11], s43 offen offset:1024 sc1 lds
    buffer_load_dwordx4 v138, s[8:11], s43 offen offset:2048 sc1 lds
    s_add_u32 s99, s92, 14
    s_and_b32 s99, s99, 15
    s_lshl_b32 s99, s99, 7
    s_add_u32 m0, s40, 81920
    s_add_u32 s43, s27, s99
    buffer_load_dwordx4 v2, s[4:7], s43 offen offset:0 sc1 lds
    buffer_load_dwordx4 v3, s[4:7], s43 offen offset:1024 sc1 lds
    buffer_load_dwordx4 v4, s[4:7], s43 offen offset:2048 sc1 lds
    buffer_load_dwordx4 v5, s[4:7], s43 offen offset:3072 sc1 lds
    s_load_dwordx2 s[30:31], s[58:59], s26 offset:0x73c
    s_load_dwordx2 s[30:31], s[58:59], s26 offset:0x7bc
    s_waitcnt vmcnt(17)
    s_barrier
    s_add_u32 s99, s92, 14
    s_and_b32 s99, s99, 15
    s_mul_i32 s100, s99, 393216
    s_add_u32 s100, s100, s28
    s_add_u32 m0, s41, 81920
    s_add_u32 s43, s100, 0
    buffer_load_dwordx4 v6, s[8:11], s43 offen offset:0 sc1 lds
    buffer_load_dwordx4 v7, s[8:11], s43 offen offset:1024 sc1 lds
    buffer_load_dwordx4 v8, s[8:11], s43 offen offset:2048 sc1 lds
    s_add_u32 m0, s41, 84992
    s_add_u32 s43, s100, 49152
    buffer_load_dwordx4 v136, s[8:11], s43 offen offset:0 sc1 lds
    buffer_load_dwordx4 v137, s[8:11], s43 offen offset:1024 sc1 lds
    buffer_load_dwordx4 v138, s[8:11], s43 offen offset:2048 sc1 lds
    s_add_u32 s99, s92, 15
    s_and_b32 s99, s99, 15
    s_lshl_b32 s99, s99, 7
    s_add_u32 m0, s40, 122880
    s_add_u32 s43, s27, s99
    buffer_load_dwordx4 v2, s[4:7], s43 offen offset:0 sc1 lds
    buffer_load_dwordx4 v3, s[4:7], s43 offen offset:1024 sc1 lds
    buffer_load_dwordx4 v4, s[4:7], s43 offen offset:2048 sc1 lds
    buffer_load_dwordx4 v5, s[4:7], s43 offen offset:3072 sc1 lds
    s_add_u32 s99, s92, 15
    s_and_b32 s99, s99, 15
    s_mul_i32 s100, s99, 393216
    s_add_u32 s100, s100, s28
    s_add_u32 m0, s41, 122880
    s_add_u32 s43, s100, 0
    buffer_load_dwordx4 v6, s[8:11], s43 offen offset:0 sc1 lds
    buffer_load_dwordx4 v7, s[8:11], s43 offen offset:1024 sc1 lds
    buffer_load_dwordx4 v8, s[8:11], s43 offen offset:2048 sc1 lds
    s_add_u32 m0, s41, 125952
    s_add_u32 s43, s100, 49152
    buffer_load_dwordx4 v136, s[8:11], s43 offen offset:0 sc1 lds
    buffer_load_dwordx4 v137, s[8:11], s43 offen offset:1024 sc1 lds
    buffer_load_dwordx4 v138, s[8:11], s43 offen offset:2048 sc1 lds
    s_waitcnt vmcnt(20)
    s_barrier
    s_and_b32 s37, s21, 1
    s_lshl_b32 s37, s37, 13
    s_lshl_b32 s96, s21, 13
    s_lshl_b32 s44, s23, 19
    s_add_u32 s44, s44, 1048576
    s_add_u32 s44, s44, s37
    s_lshr_b32 s38, s21, 1
    s_lshl_b32 s38, s38, 18
    s_add_u32 s95, s44, s38
    s_add_u32 s95, s95, 8388608
    s_lshl_b32 s38, s24, 14
    s_add_u32 s44, s44, s38
    s_sub_u32 s44, s44, 32768
    s_waitcnt vmcnt(26)
    v_readfirstlane_b32 s32, v1
    s_nop 3
    s_cmp_lg_u32 s32, 0
    s_cbranch_scc1 L_Dtag
    s_mov_b32 s16, s64
    s_mov_b32 s17, s65
    s_mov_b32 s18, 256
    s_mov_b32 s47, 0x40000
    v_mov_b32 v140, 0
L_Dt_l:
    buffer_load_dword v141, v140, s[16:19], 0 offen sc1
    s_waitcnt vmcnt(0)
    v_readfirstlane_b32 s32, v141
    s_nop 3
    s_cmp_lg_u32 s32, 0
    s_cbranch_scc1 L_Dt_ok
    s_sleep 2
    s_sub_u32 s47, s47, 1
    s_cmp_lg_u32 s47, 0
    s_cbranch_scc1 L_Dt_l
L_Dt_ok:
    v_mov_b32 v141, 0
L_Dtag:
    v_cmp_ne_u32 vcc, s32, v141
    s_nop 3
    s_cbranch_vccz L_s1_ok
    s_mov_b32 s47, 0x40000
L_s1_spin:
    s_sleep 2
    v_lshrrev_b32 v140, 2, v142
    buffer_load_dword v141, v140, s[12:15], s36 offen sc1
    s_waitcnt vmcnt(0)
    v_cmp_ne_u32 vcc, s32, v141
    s_nop 3
    s_cbranch_vccz L_s1_ok
    s_sub_u32 s47, s47, 1
    s_cmp_lg_u32 s47, 0
    s_cbranch_scc1 L_s1_spin
L_s1_ok:
    v_mov_b32 v141, v12
    v_cmp_ne_u32 vcc, s32, v141
    s_nop 3
    s_cbranch_vccz L_s1b_ok
    s_mov_b32 s47, 0x40000
L_s1b_spin:
    s_sleep 2
    v_lshrrev_b32 v140, 2, v142
    buffer_load_dword v141, v140, s[12:15], s101 offen sc1
    s_waitcnt vmcnt(0)
    v_cmp_ne_u32 vcc, s32, v141
    s_nop 3
    s_cbranch_vccz L_s1b_ok
    s_sub_u32 s47, s47, 1
    s_cmp_lg_u32 s47, 0
    s_cbranch_scc1 L_s1b_spin
L_s1b_ok:
    s_mov_b32 s99, 16384
    s_cmp_lt_u32 s21, 2
    s_cselect_b32 s99, 0, s99
    s_cselect_b32 s100, 0, 1
    s_add_u32 s99, s99, s44
    s_add_u32 s100, s100, s24
    s_cmp_lt_u32 s100, 2
    s_cselect_b32 s99, 0x7f000000, s99
    s_add_u32 m0, s96, 0
    s_add_u32 s43, s99, 0
    buffer_load_dwordx4 v142, s[12:15], s43 offen offset:0 sc1 lds
    buffer_load_dwordx4 v142, s[12:15], s43 offen offset:1024 sc1 lds
    buffer_load_dwordx4 v142, s[12:15], s43 offen offset:2048 sc1 lds
    buffer_load_dwordx4 v142, s[12:15], s43 offen offset:3072 sc1 lds
    s_add_u32 m0, s96, 4096
    s_add_u32 s43, s99, 4096
    buffer_load_dwordx4 v142, s[12:15], s43 offen offset:0 sc1 lds
    buffer_load_dwordx4 v142, s[12:15], s43 offen offset:1024 sc1 lds
    buffer_load_dwordx4 v142, s[12:15], s43 offen offset:2048 sc1 lds
    buffer_load_dwordx4 v142, s[12:15], s43 offen offset:3072 sc1 lds
    s_waitcnt vmcnt(18)
    s_barrier
    s_mov_b32 s99, 262144
    s_cmp_lt_u32 s21, 2
    s_cselect_b32 s99, 32768, s99
    s_cselect_b32 s100, 2, 0
    s_add_u32 s99, s99, s44
    s_add_u32 s100, s100, s24
    s_cmp_lt_u32 s100, 2
    s_cselect_b32 s99, 0x7f000000, s99
    s_add_u32 m0, s96, 32768
    s_add_u32 s43, s99, 0
    buffer_load_dwordx4 v142, s[12:15], s43 offen offset:0 sc1 lds
    buffer_load_dwordx4 v142, s[12:15], s43 offen offset:1024 sc1 lds
    buffer_load_dwordx4 v142, s[12:15], s43 offen offset:2048 sc1 lds
    buffer_load_dwordx4 v142, s[12:15], s43 offen offset:3072 sc1 lds
    s_add_u32 m0, s96, 36864
    s_add_u32 s43, s99, 4096
    buffer_load_dwordx4 v142, s[12:15], s43 offen offset:0 sc1 lds
    buffer_load_dwordx4 v142, s[12:15], s43 offen offset:1024 sc1 lds
    buffer_load_dwordx4 v142, s[12:15], s43 offen offset:2048 sc1 lds
    buffer_load_dwordx4 v142, s[12:15], s43 offen offset:3072 sc1 lds
    s_waitcnt vmcnt(16)
    s_barrier
    s_mov_b32 s99, 294912
    s_cmp_lt_u32 s21, 2
    s_cselect_b32 s99, 278528, s99
    s_cselect_b32 s100, 1, 2
    s_add_u32 s99, s99, s44
    s_add_u32 s100, s100, s24
    s_cmp_lt_u32 s100, 2
    s_cselect_b32 s99, 0x7f000000, s99
    s_add_u32 m0, s96, 65536
    s_add_u32 s43, s99, 0
    buffer_load_dwordx4 v142, s[12:15], s43 offen offset:0 sc1 lds
    buffer_load_dwordx4 v142, s[12:15], s43 offen offset:1024 sc1 lds
    buffer_load_dwordx4 v142, s[12:15], s43 offen offset:2048 sc1 lds
    buffer_load_dwordx4 v142, s[12:15], s43 offen offset:3072 sc1 lds
    s_add_u32 m0, s96, 69632
    s_add_u32 s43, s99, 4096
    buffer_load_dwordx4 v142, s[12:15], s43 offen offset:0 sc1 lds
    buffer_load_dwordx4 v142, s[12:15], s43 offen offset:1024 sc1 lds
    buffer_load_dwordx4 v142, s[12:15], s43 offen offset:2048 sc1 lds
    buffer_load_dwordx4 v142, s[12:15], s43 offen offset:3072 sc1 lds
    s_barrier
    v_lshrrev_b32 v15, 3, v143
    v_bfe_u32 v138, v15, 1, 1
    v_lshlrev_b32 v138, 6, v138
    v_xor_b32 v136, v138, v9
    v_add_u32 v137, 15360, v136
    v_lshrrev_b32 v15, 5, v143
    v_lshlrev_b32 v15, 2, v15
    v_bfe_u32 v11, v143, 2, 2
    v_add_u32 v15, v15, v11
    v_lshlrev_b32 v15, 7, v15
    v_lshrrev_b32 v11, 1, v11
    v_lshl_add_u32 v15, v11, 6, v15
    v_and_b32 v11, 1, v143
    v_lshl_add_u32 v15, v11, 5, v15
    v_bfe_u32 v11, v143, 4, 1
    v_lshl_add_u32 v15, v11, 4, v15
    v_bfe_u32 v11, v143, 1, 1
    v_lshl_add_u32 v15, v11, 3, v15
    s_add_u32 s29, s96, 131072
    v_add_u32 v138, s29, v15
    v_xor_b32 v11, 64, v138
    s_lshl_b32 s38, s21, 11
    s_add_u32 s38, s38, 147456
    v_add_u32 v13, s38, v142
    s_lshl_b32 s98, s69, 7
    s_lshl_b32 s38, s21, 15
    s_add_u32 s98, s98, s38
    s_mov_b32 s10, 0x200000
    s_add_u32 s36, s36, 4096
    s_add_u32 s101, s101, 4096
    s_waitcnt vmcnt(0)
    s_barrier
    s_mov_b32 s47, 0x80000
    v_lshrrev_b32 v140, 2, v142
L_s2:
    buffer_load_dword v141, v140, s[12:15], s36 offen sc1
    buffer_load_dword v12, v140, s[12:15], s101 offen sc1
    s_waitcnt vmcnt(0)
L_s2_c:
    v_cmp_ne_u32 vcc, s32, v141
    v_cmp_ne_u32 s[44:45], s32, v12
    s_nop 3
    s_or_b64 vcc, vcc, s[44:45]
    s_and_b32 vcc_lo, vcc_lo, 0xff
    s_and_b32 vcc_hi, vcc_hi, 0x0
    s_cbranch_vccz L_s2_ok
    s_sub_u32 s47, s47, 1
    s_cmp_lg_u32 s47, 0
    s_cbranch_scc1 L_s2
L_s2_ok:
    s_add_u32 m0, s96, 98304
    s_add_u32 s43, s95, 0
    buffer_load_dwordx4 v142, s[12:15], s43 offen offset:0 sc1 lds
    buffer_load_dwordx4 v142, s[12:15], s43 offen offset:1024 sc1 lds
    buffer_load_dwordx4 v142, s[12:15], s43 offen offset:2048 sc1 lds
    buffer_load_dwordx4 v142, s[12:15], s43 offen offset:3072 sc1 lds
    s_add_u32 m0, s96, 102400
    s_add_u32 s43, s95, 4096
    buffer_load_dwordx4 v142, s[12:15], s43 offen offset:0 sc1 lds
    buffer_load_dwordx4 v142, s[12:15], s43 offen offset:1024 sc1 lds
    buffer_load_dwordx4 v142, s[12:15], s43 offen offset:2048 sc1 lds
    buffer_load_dwordx4 v142, s[12:15], s43 offen offset:3072 sc1 lds
    s_add_u32 m0, s96, 131072
    s_add_u32 s43, s95, 16384
    buffer_load_dwordx4 v142, s[12:15], s43 offen offset:0 sc1 lds
    buffer_load_dwordx4 v142, s[12:15], s43 offen offset:1024 sc1 lds
    buffer_load_dwordx4 v142, s[12:15], s43 offen offset:2048 sc1 lds
    buffer_load_dwordx4 v142, s[12:15], s43 offen offset:3072 sc1 lds
    s_add_u32 m0, s96, 135168
    s_add_u32 s43, s95, 20480
    buffer_load_dwordx4 v142, s[12:15], s43 offen offset:0 sc1 lds
    buffer_load_dwordx4 v142, s[12:15], s43 offen offset:1024 sc1 lds
    buffer_load_dwordx4 v142, s[12:15], s43 offen offset:2048 sc1 lds
    buffer_load_dwordx4 v142, s[12:15], s43 offen offset:3072 sc1 lds
    v_lshrrev_b32 v140, 2, v142
    buffer_load_dword v141, v140, s[12:15], s36 offen sc1
    buffer_load_dword v12, v140, s[12:15], s101 offen sc1
    s_waitcnt vmcnt(10)
    s_barrier
    s_waitcnt vmcnt(0)
    s_mov_b32 s47, 0x80000
    v_lshrrev_b32 v140, 2, v142
    s_branch L_s2b_c
L_s2b:
    buffer_load_dword v141, v140, s[12:15], s36 offen sc1
    buffer_load_dword v12, v140, s[12:15], s101 offen sc1
    s_waitcnt vmcnt(0)
L_s2b_c:
    v_cmp_ne_u32 vcc, s32, v141
    v_cmp_ne_u32 s[44:45], s32, v12
    s_nop 3
    s_or_b64 vcc, vcc, s[44:45]
    s_and_b32 vcc_lo, vcc_lo, 0xfff00
    s_and_b32 vcc_hi, vcc_hi, 0x0
    s_cbranch_vccz L_s2b_ok
    s_sub_u32 s47, s47, 1
    s_cmp_lg_u32 s47, 0
    s_cbranch_scc1 L_s2b
L_s2b_ok:
    s_add_u32 m0, s96, 0
    s_add_u32 s43, s95, 32768
    buffer_load_dwordx4 v142, s[12:15], s43 offen offset:0 sc1 lds
    buffer_load_dwordx4 v142, s[12:15], s43 offen offset:1024 sc1 lds
    buffer_load_dwordx4 v142, s[12:15], s43 offen offset:2048 sc1 lds
    buffer_load_dwordx4 v142, s[12:15], s43 offen offset:3072 sc1 lds
    s_add_u32 m0, s96, 4096
    s_add_u32 s43, s95, 36864
    buffer_load_dwordx4 v142, s[12:15], s43 offen offset:0 sc1 lds
    buffer_load_dwordx4 v142, s[12:15], s43 offen offset:1024 sc1 lds
    buffer_load_dwordx4 v142, s[12:15], s43 offen offset:2048 sc1 lds
    buffer_load_dwordx4 v142, s[12:15], s43 offen offset:3072 sc1 lds
    s_add_u32 m0, s96, 32768
    s_add_u32 s43, s95, 49152
    buffer_load_dwordx4 v142, s[12:15], s43 offen offset:0 sc1 lds
    buffer_load_dwordx4 v142, s[12:15], s43 offen offset:1024 sc1 lds
    buffer_load_dwordx4 v142, s[12:15], s43 offen offset:2048 sc1 lds
    buffer_load_dwordx4 v142, s[12:15], s43 offen offset:3072 sc1 lds
    s_add_u32 m0, s96, 36864
    s_add_u32 s43, s95, 53248
    buffer_load_dwordx4 v142, s[12:15], s43 offen offset:0 sc1 lds
    buffer_load_dwordx4 v142, s[12:15], s43 offen offset:1024 sc1 lds
    buffer_load_dwordx4 v142, s[12:15], s43 offen offset:2048 sc1 lds
    buffer_load_dwordx4 v142, s[12:15], s43 offen offset:3072 sc1 lds
    s_add_u32 m0, s96, 65536
    s_add_u32 s43, s95, 65536
    buffer_load_dwordx4 v142, s[12:15], s43 offen offset:0 sc1 lds
    buffer_load_dwordx4 v142, s[12:15], s43 offen offset:1024 sc1 lds
    buffer_load_dwordx4 v142, s[12:15], s43 offen offset:2048 sc1 lds
    buffer_load_dwordx4 v142, s[12:15], s43 offen offset:3072 sc1 lds
    s_add_u32 m0, s96, 69632
    s_add_u32 s43, s95, 69632
    buffer_load_dwordx4 v142, s[12:15], s43 offen offset:0 sc1 lds
    buffer_load_dwordx4 v142, s[12:15], s43 offen offset:1024 sc1 lds
    buffer_load_dwordx4 v142, s[12:15], s43 offen offset:2048 sc1 lds
    buffer_load_dwordx4 v142, s[12:15], s43 offen offset:3072 sc1 lds
    v_lshrrev_b32 v140, 2, v142
    buffer_load_dword v141, v140, s[12:15], s36 offen sc1
    buffer_load_dword v12, v140, s[12:15], s101 offen sc1
    s_lshl_b32 s27, s68, 2
    s_add_u32 s27, s27, s21
    s_lshl_b32 s27, s27, 17
    s_add_u32 s27, s27, 20971520
    s_waitcnt vmcnt(28)
    s_barrier
    s_waitcnt vmcnt(18)
    s_barrier
    s_waitcnt vmcnt(0)
    s_mov_b32 s47, 0x80000
    v_lshrrev_b32 v140, 2, v142
    s_branch L_s2c_c
L_s2c:
    buffer_load_dword v141, v140, s[12:15], s36 offen sc1
    buffer_load_dword v12, v140, s[12:15], s101 offen sc1
    s_waitcnt vmcnt(0)
L_s2c_c:
    v_cmp_ne_u32 vcc, s32, v141
    v_cmp_ne_u32 s[44:45], s32, v12
    s_nop 3
    s_or_b64 vcc, vcc, s[44:45]
    s_and_b32 vcc_lo, vcc_lo, 0xffffffff
    s_and_b32 vcc_hi, vcc_hi, 0xffffffff
    s_cbranch_vccz L_s2c_ok
    s_sub_u32 s47, s47, 1
    s_cmp_lg_u32 s47, 0
    s_cbranch_scc1 L_s2c
L_s2c_ok:
    s_lshl_b32 s36, s68, 8
    s_add_u32 s36, s36, 34611200
    s_add_u32 m0, s96, 98304
    s_add_u32 s43, s95, 81920
    buffer_load_dwordx4 v142, s[12:15], s43 offen offset:0 sc1 lds
    buffer_load_dwordx4 v142, s[12:15], s43 offen offset:1024 sc1 lds
    buffer_load_dwordx4 v142, s[12:15], s43 offen offset:2048 sc1 lds
    buffer_load_dwordx4 v142, s[12:15], s43 offen offset:3072 sc1 lds
    s_add_u32 m0, s96, 102400
    s_add_u32 s43, s95, 86016
    buffer_load_dwordx4 v142, s[12:15], s43 offen offset:0 sc1 lds
    buffer_load_dwordx4 v142, s[12:15], s43 offen offset:1024 sc1 lds
    buffer_load_dwordx4 v142, s[12:15], s43 offen offset:2048 sc1 lds
    buffer_load_dwordx4 v142, s[12:15], s43 offen offset:3072 sc1 lds
    s_waitcnt vmcnt(18)
    s_barrier
    s_mov_b32 s8, s52
    s_mov_b32 s9, s53
    s_add_u32 m0, s29, 0
    s_add_u32 s43, s98, 0
    buffer_load_dwordx4 v136, s[8:11], s43 offen offset:0 lds
    buffer_load_dwordx4 v137, s[8:11], s43 offen offset:1024 lds
    s_add_u32 m0, s29, 2048
    s_add_u32 s43, s98, 131072
    buffer_load_dwordx4 v136, s[8:11], s43 offen offset:0 lds
    buffer_load_dwordx4 v137, s[8:11], s43 offen offset:1024 lds
    s_add_u32 m0, s29, 4096
    s_add_u32 s43, s98, 262144
    buffer_load_dwordx4 v136, s[8:11], s43 offen offset:0 lds
    buffer_load_dwordx4 v137, s[8:11], s43 offen offset:1024 lds
    s_add_u32 m0, s29, 6144
    s_add_u32 s43, s98, 393216
    buffer_load_dwordx4 v136, s[8:11], s43 offen offset:0 lds
    buffer_load_dwordx4 v137, s[8:11], s43 offen offset:1024 lds
    s_waitcnt vmcnt(18)
    s_barrier
    s_waitcnt vmcnt(0)
    ds_read_b64_tr_b16 v[16:17], v138 offset:0
    ds_read_b64_tr_b16 v[18:19], v138 offset:1024
    ds_read_b64_tr_b16 v[20:21], v11 offset:0
    ds_read_b64_tr_b16 v[22:23], v11 offset:1024
    ds_read_b64_tr_b16 v[24:25], v138 offset:2048
    ds_read_b64_tr_b16 v[26:27], v138 offset:3072
    ds_read_b64_tr_b16 v[28:29], v11 offset:2048
    ds_read_b64_tr_b16 v[30:31], v11 offset:3072
    ds_read_b64_tr_b16 v[32:33], v138 offset:4096
    ds_read_b64_tr_b16 v[34:35], v138 offset:5120
    ds_read_b64_tr_b16 v[36:37], v11 offset:4096
    ds_read_b64_tr_b16 v[38:39], v11 offset:5120
    ds_read_b64_tr_b16 v[40:41], v138 offset:6144
    ds_read_b64_tr_b16 v[42:43], v138 offset:7168
    ds_read_b64_tr_b16 v[44:45], v11 offset:6144
    ds_read_b64_tr_b16 v[46:47], v11 offset:7168
    s_waitcnt lgkmcnt(0)
    s_add_u32 m0, s96, 0
    s_add_u32 s43, s95, 98304
    buffer_load_dwordx4 v142, s[12:15], s43 offen offset:0 sc1 lds
    buffer_load_dwordx4 v142, s[12:15], s43 offen offset:1024 sc1 lds
    buffer_load_dwordx4 v142, s[12:15], s43 offen offset:2048 sc1 lds
    buffer_load_dwordx4 v142, s[12:15], s43 offen offset:3072 sc1 lds
    s_add_u32 m0, s96, 4096
    s_add_u32 s43, s95, 102400
    buffer_load_dwordx4 v142, s[12:15], s43 offen offset:0 sc1 lds
    buffer_load_dwordx4 v142, s[12:15], s43 offen offset:1024 sc1 lds
    buffer_load_dwordx4 v142, s[12:15], s43 offen offset:2048 sc1 lds
    buffer_load_dwordx4 v142, s[12:15], s43 offen offset:3072 sc1 lds
    s_add_u32 m0, s29, 0
    s_add_u32 s43, s98, 524288
    buffer_load_dwordx4 v136, s[8:11], s43 offen offset:0 lds
    buffer_load_dwordx4 v137, s[8:11], s43 offen offset:1024 lds
    s_add_u32 m0, s29, 2048
    s_add_u32 s43, s98, 655360
    buffer_load_dwordx4 v136, s[8:11], s43 offen offset:0 lds
    buffer_load_dwordx4 v137, s[8:11], s43 offen offset:1024 lds
    s_add_u32 m0, s29, 4096
    s_add_u32 s43, s98, 786432
    buffer_load_dwordx4 v136, s[8:11], s43 offen offset:0 lds
    buffer_load_dwordx4 v137, s[8:11], s43 offen offset:1024 lds
    s_add_u32 m0, s29, 6144
    s_add_u32 s43, s98, 917504
    buffer_load_dwordx4 v136, s[8:11], s43 offen offset:0 lds
    buffer_load_dwordx4 v137, s[8:11], s43 offen offset:1024 lds
    s_waitcnt vmcnt(24)
    s_barrier
    s_waitcnt vmcnt(0)
    ds_read_b64_tr_b16 v[48:49], v138 offset:0
    ds_read_b64_tr_b16 v[50:51], v138 offset:1024
    ds_read_b64_tr_b16 v[52:53], v11 offset:0
    ds_read_b64_tr_b16 v[54:55], v11 offset:1024
    ds_read_b64_tr_b16 v[56:57], v138 offset:2048
    ds_read_b64_tr_b16 v[58:59], v138 offset:3072
    ds_read_b64_tr_b16 v[60:61], v11 offset:2048
    ds_read_b64_tr_b16 v[62:63], v11 offset:3072
    ds_read_b64_tr_b16 v[64:65], v138 offset:4096
    ds_read_b64_tr_b16 v[66:67], v138 offset:5120
    ds_read_b64_tr_b16 v[68:69], v11 offset:4096
    ds_read_b64_tr_b16 v[70:71], v11 offset:5120
    ds_read_b64_tr_b16 v[72:73], v138 offset:6144
    ds_read_b64_tr_b16 v[74:75], v138 offset:7168
    ds_read_b64_tr_b16 v[76:77], v11 offset:6144
    ds_read_b64_tr_b16 v[78:79], v11 offset:7168
    s_waitcnt lgkmcnt(0)
    s_add_u32 m0, s96, 32768
    s_add_u32 s43, s95, 114688
    buffer_load_dwordx4 v142, s[12:15], s43 offen offset:0 sc1 lds
    buffer_load_dwordx4 v142, s[12:15], s43 offen offset:1024 sc1 lds
    buffer_load_dwordx4 v142, s[12:15], s43 offen offset:2048 sc1 lds
    buffer_load_dwordx4 v142, s[12:15], s43 offen offset:3072 sc1 lds
    s_add_u32 m0, s96, 36864
    s_add_u32 s43, s95, 118784
    buffer_load_dwordx4 v142, s[12:15], s43 offen offset:0 sc1 lds
    buffer_load_dwordx4 v142, s[12:15], s43 offen offset:1024 sc1 lds
    buffer_load_dwordx4 v142, s[12:15], s43 offen offset:2048 sc1 lds
    buffer_load_dwordx4 v142, s[12:15], s43 offen offset:3072 sc1 lds
    s_add_u32 m0, s29, 0
    s_add_u32 s43, s98, 1048576
    buffer_load_dwordx4 v136, s[8:11], s43 offen offset:0 lds
    buffer_load_dwordx4 v137, s[8:11], s43 offen offset:1024 lds
    s_add_u32 m0, s29, 2048
    s_add_u32 s43, s98, 1179648
    buffer_load_dwordx4 v136, s[8:11], s43 offen offset:0 lds
    buffer_load_dwordx4 v137, s[8:11], s43 offen offset:1024 lds
    s_add_u32 m0, s29, 4096
    s_add_u32 s43, s98, 1310720
    buffer_load_dwordx4 v136, s[8:11], s43 offen offset:0 lds
    buffer_load_dwordx4 v137, s[8:11], s43 offen offset:1024 lds
    s_add_u32 m0, s29, 6144
    s_add_u32 s43, s98, 1441792
    buffer_load_dwordx4 v136, s[8:11], s43 offen offset:0 lds
    buffer_load_dwordx4 v137, s[8:11], s43 offen offset:1024 lds
    s_waitcnt vmcnt(24)
    s_barrier
    s_waitcnt vmcnt(0)
    ds_read_b64_tr_b16 v[80:81], v138 offset:0
    ds_read_b64_tr_b16 v[82:83], v138 offset:1024
    ds_read_b64_tr_b16 v[84:85], v11 offset:0
    ds_read_b64_tr_b16 v[86:87], v11 offset:1024
    ds_read_b64_tr_b16 v[88:89], v138 offset:2048
    ds_read_b64_tr_b16 v[90:91], v138 offset:3072
    ds_read_b64_tr_b16 v[92:93], v11 offset:2048
    ds_read_b64_tr_b16 v[94:95], v11 offset:3072
    ds_read_b64_tr_b16 v[96:97], v138 offset:4096
    ds_read_b64_tr_b16 v[98:99], v138 offset:5120
    ds_read_b64_tr_b16 v[100:101], v11 offset:4096
    ds_read_b64_tr_b16 v[102:103], v11 offset:5120
    ds_read_b64_tr_b16 v[104:105], v138 offset:6144
    ds_read_b64_tr_b16 v[106:107], v138 offset:7168
    ds_read_b64_tr_b16 v[108:109], v11 offset:6144
    ds_read_b64_tr_b16 v[110:111], v11 offset:7168
    s_waitcnt lgkmcnt(0)
    s_add_u32 m0, s96, 65536
    s_add_u32 s43, s95, 131072
    buffer_load_dwordx4 v142, s[12:15], s43 offen offset:0 sc1 lds
    buffer_load_dwordx4 v142, s[12:15], s43 offen offset:1024 sc1 lds
    buffer_load_dwordx4 v142, s[12:15], s43 offen offset:2048 sc1 lds
    buffer_load_dwordx4 v142, s[12:15], s43 offen offset:3072 sc1 lds
    s_add_u32 m0, s96, 69632
    s_add_u32 s43, s95, 135168
    buffer_load_dwordx4 v142, s[12:15], s43 offen offset:0 sc1 lds
    buffer_load_dwordx4 v142, s[12:15], s43 offen offset:1024 sc1 lds
    buffer_load_dwordx4 v142, s[12:15], s43 offen offset:2048 sc1 lds
    buffer_load_dwordx4 v142, s[12:15], s43 offen offset:3072 sc1 lds
    s_add_u32 m0, s29, 0
    s_add_u32 s43, s98, 1572864
    buffer_load_dwordx4 v136, s[8:11], s43 offen offset:0 lds
    buffer_load_dwordx4 v137, s[8:11], s43 offen offset:1024 lds
    s_add_u32 m0, s29, 2048
    s_add_u32 s43, s98, 1703936
    buffer_load_dwordx4 v136, s[8:11], s43 offen offset:0 lds
    buffer_load_dwordx4 v137, s[8:11], s43 offen offset:1024 lds
    s_add_u32 m0, s29, 4096
    s_add_u32 s43, s98, 1835008
    buffer_load_dwordx4 v136, s[8:11], s43 offen offset:0 lds
    buffer_load_dwordx4 v137, s[8:11], s43 offen offset:1024 lds
    s_add_u32 m0, s29, 6144
    s_add_u32 s43, s98, 1966080
    buffer_load_dwordx4 v136, s[8:11], s43 offen offset:0 lds
    buffer_load_dwordx4 v137, s[8:11], s43 offen offset:1024 lds
    s_waitcnt vmcnt(24)
    s_barrier
    s_waitcnt vmcnt(0)
    ds_read_b64_tr_b16 v[112:113], v138 offset:0
    ds_read_b64_tr_b16 v[114:115], v138 offset:1024
    ds_read_b64_tr_b16 v[116:117], v11 offset:0
    ds_read_b64_tr_b16 v[118:119], v11 offset:1024
    ds_read_b64_tr_b16 v[120:121], v138 offset:2048
    ds_read_b64_tr_b16 v[122:123], v138 offset:3072
    ds_read_b64_tr_b16 v[124:125], v11 offset:2048
    ds_read_b64_tr_b16 v[126:127], v11 offset:3072
    ds_read_b64_tr_b16 v[128:129], v138 offset:4096
    ds_read_b64_tr_b16 v[130:131], v138 offset:5120
    ds_read_b64_tr_b16 v[132:133], v11 offset:4096
    ds_read_b64_tr_b16 v[134:135], v11 offset:5120
    ds_read_b64_tr_b16 a[0:1], v138 offset:6144
    ds_read_b64_tr_b16 a[2:3], v138 offset:7168
    ds_read_b64_tr_b16 a[4:5], v11 offset:6144
    ds_read_b64_tr_b16 a[6:7], v11 offset:7168
    s_waitcnt lgkmcnt(0)
    s_add_u32 m0, s96, 98304
    s_add_u32 s43, s95, 147456
    buffer_load_dwordx4 v142, s[12:15], s43 offen offset:0 sc1 lds
    buffer_load_dwordx4 v142, s[12:15], s43 offen offset:1024 sc1 lds
    buffer_load_dwordx4 v142, s[12:15], s43 offen offset:2048 sc1 lds
    buffer_load_dwordx4 v142, s[12:15], s43 offen offset:3072 sc1 lds
    s_add_u32 m0, s96, 102400
    s_add_u32 s43, s95, 151552
    buffer_load_dwordx4 v142, s[12:15], s43 offen offset:0 sc1 lds
    buffer_load_dwordx4 v142, s[12:15], s43 offen offset:1024 sc1 lds
    buffer_load_dwordx4 v142, s[12:15], s43 offen offset:2048 sc1 lds
    buffer_load_dwordx4 v142, s[12:15], s43 offen offset:3072 sc1 lds
    s_mov_b32 s8, s58
    s_mov_b32 s9, s59
    s_add_u32 m0, s29, 0
    s_add_u32 s43, s98, 0
    buffer_load_dwordx4 v136, s[8:11], s43 offen offset:0 lds
    buffer_load_dwordx4 v137, s[8:11], s43 offen offset:1024 lds
    s_add_u32 m0, s29, 2048
    s_add_u32 s43, s98, 131072
    buffer_load_dwordx4 v136, s[8:11], s43 offen offset:0 lds
    buffer_load_dwordx4 v137, s[8:11], s43 offen offset:1024 lds
    s_add_u32 m0, s29, 4096
    s_add_u32 s43, s98, 262144
    buffer_load_dwordx4 v136, s[8:11], s43 offen offset:0 lds
    buffer_load_dwordx4 v137, s[8:11], s43 offen offset:1024 lds
    s_add_u32 m0, s29, 6144
    s_add_u32 s43, s98, 393216
    buffer_load_dwordx4 v136, s[8:11], s43 offen offset:0 lds
    buffer_load_dwordx4 v137, s[8:11], s43 offen offset:1024 lds
    s_waitcnt vmcnt(24)
    s_barrier
    s_waitcnt vmcnt(0)
    ds_read_b64_tr_b16 a[8:9], v138 offset:0
    ds_read_b64_tr_b16 a[10:11], v138 offset:1024
    ds_read_b64_tr_b16 a[12:13], v11 offset:0
    ds_read_b64_tr_b16 a[14:15], v11 offset:1024
    ds_read_b64_tr_b16 a[16:17], v138 offset:2048
    ds_read_b64_tr_b16 a[18:19], v138 offset:3072
    ds_read_b64_tr_b16 a[20:21], v11 offset:2048
    ds_read_b64_tr_b16 a[22:23], v11 offset:3072
    ds_read_b64_tr_b16 a[24:25], v138 offset:4096
    ds_read_b64_tr_b16 a[26:27], v138 offset:5120
    ds_read_b64_tr_b16 a[28:29], v11 offset:4096
    ds_read_b64_tr_b16 a[30:31], v11 offset:5120
    ds_read_b64_tr_b16 a[32:33], v138 offset:6144
    ds_read_b64_tr_b16 a[34:35], v138 offset:7168
    ds_read_b64_tr_b16 a[36:37], v11 offset:6144
    ds_read_b64_tr_b16 a[38:39], v11 offset:7168
    s_waitcnt lgkmcnt(0)
    s_add_u32 m0, s96, 0
    s_add_u32 s43, s95, 163840
    buffer_load_dwordx4 v142, s[12:15], s43 offen offset:0 sc1 lds
    buffer_load_dwordx4 v142, s[12:15], s43 offen offset:1024 sc1 lds
    buffer_load_dwordx4 v142, s[12:15], s43 offen offset:2048 sc1 lds
    buffer_load_dwordx4 v142, s[12:15], s43 offen offset:3072 sc1 lds
    s_add_u32 m0, s96, 4096
    s_add_u32 s43, s95, 167936
    buffer_load_dwordx4 v142, s[12:15], s43 offen offset:0 sc1 lds
    buffer_load_dwordx4 v142, s[12:15], s43 offen offset:1024 sc1 lds
    buffer_load_dwordx4 v142, s[12:15], s43 offen offset:2048 sc1 lds
    buffer_load_dwordx4 v142, s[12:15], s43 offen offset:3072 sc1 lds
    s_add_u32 m0, s29, 0
    s_add_u32 s43, s98, 524288
    buffer_load_dwordx4 v136, s[8:11], s43 offen offset:0 lds
    buffer_load_dwordx4 v137, s[8:11], s43 offen offset:1024 lds
    s_add_u32 m0, s29, 2048
    s_add_u32 s43, s98, 655360
    buffer_load_dwordx4 v136, s[8:11], s43 offen offset:0 lds
    buffer_load_dwordx4 v137, s[8:11], s43 offen offset:1024 lds
    s_add_u32 m0, s29, 4096
    s_add_u32 s43, s98, 786432
    buffer_load_dwordx4 v136, s[8:11], s43 offen offset:0 lds
    buffer_load_dwordx4 v137, s[8:11], s43 offen offset:1024 lds
    s_add_u32 m0, s29, 6144
    s_add_u32 s43, s98, 917504
    buffer_load_dwordx4 v136, s[8:11], s43 offen offset:0 lds
    buffer_load_dwordx4 v137, s[8:11], s43 offen offset:1024 lds
    s_waitcnt vmcnt(24)
    s_barrier
    s_waitcnt vmcnt(0)
    ds_read_b64_tr_b16 a[40:41], v138 offset:0
    ds_read_b64_tr_b16 a[42:43], v138 offset:1024
    ds_read_b64_tr_b16 a[44:45], v11 offset:0
    ds_read_b64_tr_b16 a[46:47], v11 offset:1024
    ds_read_b64_tr_b16 a[48:49], v138 offset:2048
    ds_read_b64_tr_b16 a[50:51], v138 offset:3072
    ds_read_b64_tr_b16 a[52:53], v11 offset:2048
    ds_read_b64_tr_b16 a[54:55], v11 offset:3072
    ds_read_b64_tr_b16 a[56:57], v138 offset:4096
    ds_read_b64_tr_b16 a[58:59], v138 offset:5120
    ds_read_b64_tr_b16 a[60:61], v11 offset:4096
    ds_read_b64_tr_b16 a[62:63], v11 offset:5120
    ds_read_b64_tr_b16 a[64:65], v138 offset:6144
    ds_read_b64_tr_b16 a[66:67], v138 offset:7168
    ds_read_b64_tr_b16 a[68:69], v11 offset:6144
    ds_read_b64_tr_b16 a[70:71], v11 offset:7168
    s_waitcnt lgkmcnt(0)
    s_add_u32 m0, s96, 32768
    s_add_u32 s43, s95, 180224
    buffer_load_dwordx4 v142, s[12:15], s43 offen offset:0 sc1 lds
    buffer_load_dwordx4 v142, s[12:15], s43 offen offset:1024 sc1 lds
    buffer_load_dwordx4 v142, s[12:15], s43 offen offset:2048 sc1 lds
    buffer_load_dwordx4 v142, s[12:15], s43 offen offset:3072 sc1 lds
    s_add_u32 m0, s96, 36864
    s_add_u32 s43, s95, 184320
    buffer_load_dwordx4 v142, s[12:15], s43 offen offset:0 sc1 lds
    buffer_load_dwordx4 v142, s[12:15], s43 offen offset:1024 sc1 lds
    buffer_load_dwordx4 v142, s[12:15], s43 offen offset:2048 sc1 lds
    buffer_load_dwordx4 v142, s[12:15], s43 offen offset:3072 sc1 lds
    s_add_u32 m0, s29, 0
    s_add_u32 s43, s98, 1048576
    buffer_load_dwordx4 v136, s[8:11], s43 offen offset:0 lds
    buffer_load_dwordx4 v137, s[8:11], s43 offen offset:1024 lds
    s_add_u32 m0, s29, 2048
    s_add_u32 s43, s98, 1179648
    buffer_load_dwordx4 v136, s[8:11], s43 offen offset:0 lds
    buffer_load_dwordx4 v137, s[8:11], s43 offen offset:1024 lds
    s_add_u32 m0, s29, 4096
    s_add_u32 s43, s98, 1310720
    buffer_load_dwordx4 v136, s[8:11], s43 offen offset:0 lds
    buffer_load_dwordx4 v137, s[8:11], s43 offen offset:1024 lds
    s_add_u32 m0, s29, 6144
    s_add_u32 s43, s98, 1441792
    buffer_load_dwordx4 v136, s[8:11], s43 offen offset:0 lds
    buffer_load_dwordx4 v137, s[8:11], s43 offen offset:1024 lds
    s_waitcnt vmcnt(24)
    s_barrier
    s_waitcnt vmcnt(0)
    ds_read_b64_tr_b16 a[72:73], v138 offset:0
    ds_read_b64_tr_b16 a[74:75], v138 offset:1024
    ds_read_b64_tr_b16 a[76:77], v11 offset:0
    ds_read_b64_tr_b16 a[78:79], v11 offset:1024
    ds_read_b64_tr_b16 a[80:81], v138 offset:2048
    ds_read_b64_tr_b16 a[82:83], v138 offset:3072
    ds_read_b64_tr_b16 a[84:85], v11 offset:2048
    ds_read_b64_tr_b16 a[86:87], v11 offset:3072
    ds_read_b64_tr_b16 a[88:89], v138 offset:4096
    ds_read_b64_tr_b16 a[90:91], v138 offset:5120
    ds_read_b64_tr_b16 a[92:93], v11 offset:4096
    ds_read_b64_tr_b16 a[94:95], v11 offset:5120
    ds_read_b64_tr_b16 a[96:97], v138 offset:6144
    ds_read_b64_tr_b16 a[98:99], v138 offset:7168
    ds_read_b64_tr_b16 a[100:101], v11 offset:6144
    ds_read_b64_tr_b16 a[102:103], v11 offset:7168
    s_waitcnt lgkmcnt(0)
    s_add_u32 m0, s96, 65536
    s_add_u32 s43, s95, 196608
    buffer_load_dwordx4 v142, s[12:15], s43 offen offset:0 sc1 lds
    buffer_load_dwordx4 v142, s[12:15], s43 offen offset:1024 sc1 lds
    buffer_load_dwordx4 v142, s[12:15], s43 offen offset:2048 sc1 lds
    buffer_load_dwordx4 v142, s[12:15], s43 offen offset:3072 sc1 lds
    s_add_u32 m0, s96, 69632
    s_add_u32 s43, s95, 200704
    buffer_load_dwordx4 v142, s[12:15], s43 offen offset:0 sc1 lds
    buffer_load_dwordx4 v142, s[12:15], s43 offen offset:1024 sc1 lds
    buffer_load_dwordx4 v142, s[12:15], s43 offen offset:2048 sc1 lds
    buffer_load_dwordx4 v142, s[12:15], s43 offen offset:3072 sc1 lds
    s_add_u32 m0, s29, 0
    s_add_u32 s43, s98, 1572864
    buffer_load_dwordx4 v136, s[8:11], s43 offen offset:0 lds
    buffer_load_dwordx4 v137, s[8:11], s43 offen offset:1024 lds
    s_add_u32 m0, s29, 2048
    s_add_u32 s43, s98, 1703936
    buffer_load_dwordx4 v136, s[8:11], s43 offen offset:0 lds
    buffer_load_dwordx4 v137, s[8:11], s43 offen offset:1024 lds
    v_lshrrev_b32 v140, 2, v142
    buffer_load_dword v141, v140, s[12:15], s36 offen sc1
    s_waitcnt vmcnt(21)
    s_barrier
    s_waitcnt vmcnt(1)
    ds_read_b64_tr_b16 a[104:105], v138 offset:0
    ds_read_b64_tr_b16 a[106:107], v138 offset:1024
    ds_read_b64_tr_b16 a[108:109], v11 offset:0
    ds_read_b64_tr_b16 a[110:111], v11 offset:1024
    ds_read_b64_tr_b16 v[0:1], v138 offset:2048
    ds_read_b64_tr_b16 v[2:3], v138 offset:3072
    ds_read_b64_tr_b16 v[4:5], v11 offset:2048
    ds_read_b64_tr_b16 v[6:7], v11 offset:3072
    s_waitcnt lgkmcnt(0)
    s_add_u32 m0, s96, 98304
    s_add_u32 s43, s95, 212992
    buffer_load_dwordx4 v142, s[12:15], s43 offen offset:0 sc1 lds
    buffer_load_dwordx4 v142, s[12:15], s43 offen offset:1024 sc1 lds
    buffer_load_dwordx4 v142, s[12:15], s43 offen offset:2048 sc1 lds
    buffer_load_dwordx4 v142, s[12:15], s43 offen offset:3072 sc1 lds
    s_add_u32 m0, s96, 102400
    s_add_u32 s43, s95, 217088
    buffer_load_dwordx4 v142, s[12:15], s43 offen offset:0 sc1 lds
    buffer_load_dwordx4 v142, s[12:15], s43 offen offset:1024 sc1 lds
    buffer_load_dwordx4 v142, s[12:15], s43 offen offset:2048 sc1 lds
    buffer_load_dwordx4 v142, s[12:15], s43 offen offset:3072 sc1 lds
    s_waitcnt vmcnt(13)
    s_barrier
    s_waitcnt vmcnt(0)
    ds_write_b128 v13, v[16:19] offset:0
    ds_write_b128 v13, v[20:23] offset:1024
    ds_write_b128 v13, v[24:27] offset:8192
    ds_write_b128 v13, v[28:31] offset:9216
    s_waitcnt lgkmcnt(0)
    s_add_u32 s29, s40, 131072
    s_sub_u32 s38, s40, s96
    v_add_u32 v138, s38, v138
    v_add_u32 v11, s38, v11
    s_add_u32 m0, s29, 0
    s_add_u32 s43, s98, 1835008
    buffer_load_dwordx4 v136, s[8:11], s43 offen offset:0 lds
    buffer_load_dwordx4 v137, s[8:11], s43 offen offset:1024 lds
    s_add_u32 m0, s29, 2048
    s_add_u32 s43, s98, 1966080
    buffer_load_dwordx4 v136, s[8:11], s43 offen offset:0 lds
    buffer_load_dwordx4 v137, s[8:11], s43 offen offset:1024 lds
    s_add_u32 m0, s96, 0
    s_add_u32 s43, s95, 229376
    buffer_load_dwordx4 v142, s[12:15], s43 offen offset:0 sc1 lds
    buffer_load_dwordx4 v142, s[12:15], s43 offen offset:1024 sc1 lds
    buffer_load_dwordx4 v142, s[12:15], s43 offen offset:2048 sc1 lds
    buffer_load_dwordx4 v142, s[12:15], s43 offen offset:3072 sc1 lds
    s_add_u32 m0, s96, 4096
    s_add_u32 s43, s95, 233472
    buffer_load_dwordx4 v142, s[12:15], s43 offen offset:0 sc1 lds
    buffer_load_dwordx4 v142, s[12:15], s43 offen offset:1024 sc1 lds
    buffer_load_dwordx4 v142, s[12:15], s43 offen offset:2048 sc1 lds
    buffer_load_dwordx4 v142, s[12:15], s43 offen offset:3072 sc1 lds
    s_waitcnt vmcnt(12)
    s_barrier
    s_waitcnt vmcnt(8)
    ds_read_b64_tr_b16 v[16:17], v138 offset:0
    ds_read_b64_tr_b16 v[18:19], v138 offset:1024
    ds_read_b64_tr_b16 v[20:21], v11 offset:0
    ds_read_b64_tr_b16 v[22:23], v11 offset:1024
    ds_read_b64_tr_b16 v[24:25], v138 offset:2048
    ds_read_b64_tr_b16 v[26:27], v138 offset:3072
    ds_read_b64_tr_b16 v[28:29], v11 offset:2048
    ds_read_b64_tr_b16 v[30:31], v11 offset:3072
    s_waitcnt lgkmcnt(0)
    s_add_u32 m0, s96, 32768
    s_add_u32 s43, s95, 245760
    buffer_load_dwordx4 v142, s[12:15], s43 offen offset:0 sc1 lds
    buffer_load_dwordx4 v142, s[12:15], s43 offen offset:1024 sc1 lds
    buffer_load_dwordx4 v142, s[12:15], s43 offen offset:2048 sc1 lds
    buffer_load_dwordx4 v142, s[12:15], s43 offen offset:3072 sc1 lds
    s_add_u32 m0, s96, 36864
    s_add_u32 s43, s95, 249856
    buffer_load_dwordx4 v142, s[12:15], s43 offen offset:0 sc1 lds
    buffer_load_dwordx4 v142, s[12:15], s43 offen offset:1024 sc1 lds
    buffer_load_dwordx4 v142, s[12:15], s43 offen offset:2048 sc1 lds
    buffer_load_dwordx4 v142, s[12:15], s43 offen offset:3072 sc1 lds
    s_waitcnt vmcnt(8)
    s_barrier
    v_cmp_ne_u32 vcc, s32, v141
    s_nop 3
    s_cbranch_vccz L_s4_ok
    s_mov_b32 s47, 0x40000
L_s4_spin:
    s_sleep 2
    v_lshrrev_b32 v140, 2, v142
    buffer_load_dword v141, v140, s[12:15], s36 offen sc1
    s_waitcnt vmcnt(0)
    v_cmp_ne_u32 vcc, s32, v141
    s_nop 3
    s_cbranch_vccz L_s4_ok
    s_sub_u32 s47, s47, 1
    s_cmp_lg_u32 s47, 0
    s_cbranch_scc1 L_s4_spin
L_s4_ok:
    s_add_u32 m0, s40, 131072
    s_add_u32 s43, s27, 0
    buffer_load_dwordx4 v142, s[12:15], s43 offen offset:0 sc1 lds
    buffer_load_dwordx4 v142, s[12:15], s43 offen offset:1024 sc1 lds
    buffer_load_dwordx4 v142, s[12:15], s43 offen offset:2048 sc1 lds
    buffer_load_dwordx4 v142, s[12:15], s43 offen offset:3072 sc1 lds
    s_add_u32 m0, s40, 65536
    s_add_u32 s43, s27, 4096
    buffer_load_dwordx4 v142, s[12:15], s43 offen offset:0 sc1 lds
    buffer_load_dwordx4 v142, s[12:15], s43 offen offset:1024 sc1 lds
    buffer_load_dwordx4 v142, s[12:15], s43 offen offset:2048 sc1 lds
    buffer_load_dwordx4 v142, s[12:15], s43 offen offset:3072 sc1 lds
    s_add_u32 m0, s40, 81920
    s_add_u32 s43, s27, 8192
    buffer_load_dwordx4 v142, s[12:15], s43 offen offset:0 sc1 lds
    buffer_load_dwordx4 v142, s[12:15], s43 offen offset:1024 sc1 lds
    buffer_load_dwordx4 v142, s[12:15], s43 offen offset:2048 sc1 lds
    buffer_load_dwordx4 v142, s[12:15], s43 offen offset:3072 sc1 lds
    s_waitcnt vmcnt(12)
    s_barrier
    s_add_u32 m0, s40, 98304
    s_add_u32 s43, s27, 12288
    buffer_load_dwordx4 v142, s[12:15], s43 offen offset:0 sc1 lds
    buffer_load_dwordx4 v142, s[12:15], s43 offen offset:1024 sc1 lds
    buffer_load_dwordx4 v142, s[12:15], s43 offen offset:2048 sc1 lds
    buffer_load_dwordx4 v142, s[12:15], s43 offen offset:3072 sc1 lds
    s_add_u32 m0, s40, 114688
    s_add_u32 s43, s27, 16384
    buffer_load_dwordx4 v142, s[12:15], s43 offen offset:0 sc1 lds
    buffer_load_dwordx4 v142, s[12:15], s43 offen offset:1024 sc1 lds
    buffer_load_dwordx4 v142, s[12:15], s43 offen offset:2048 sc1 lds
    buffer_load_dwordx4 v142, s[12:15], s43 offen offset:3072 sc1 lds
    s_barrier
    s_add_u32 m0, s40, 0
    s_add_u32 s43, s27, 20480
    buffer_load_dwordx4 v142, s[12:15], s43 offen offset:0 sc1 lds
    buffer_load_dwordx4 v142, s[12:15], s43 offen offset:1024 sc1 lds
    buffer_load_dwordx4 v142, s[12:15], s43 offen offset:2048 sc1 lds
    buffer_load_dwordx4 v142, s[12:15], s43 offen offset:3072 sc1 lds
    s_add_u32 m0, s40, 16384
    s_add_u32 s43, s27, 24576
    buffer_load_dwordx4 v142, s[12:15], s43 offen offset:0 sc1 lds
    buffer_load_dwordx4 v142, s[12:15], s43 offen offset:1024 sc1 lds
    buffer_load_dwordx4 v142, s[12:15], s43 offen offset:2048 sc1 lds
    buffer_load_dwordx4 v142, s[12:15], s43 offen offset:3072 sc1 lds
    s_add_u32 s36, s36, 4096
    v_subrev_u32 v12, 114688, v13
    s_waitcnt vmcnt(0)
    s_barrier
    ds_write_b128 v12, v[32:35] offset:0
    ds_write_b128 v12, v[36:39] offset:1024
    ds_write_b128 v12, v[40:43] offset:8192
    ds_write_b128 v12, v[44:47] offset:9216
    s_waitcnt lgkmcnt(0)
    s_barrier
    ds_write_b128 v12, v[48:51] offset:16384
    ds_write_b128 v12, v[52:55] offset:17408
    ds_write_b128 v12, v[56:59] offset:24576
    ds_write_b128 v12, v[60:63] offset:25600
    s_waitcnt lgkmcnt(0)
    s_barrier
    ds_write_b128 v13, v[64:67] offset:0
    ds_write_b128 v13, v[68:71] offset:1024
    ds_write_b128 v13, v[72:75] offset:8192
    ds_write_b128 v13, v[76:79] offset:9216
    s_waitcnt lgkmcnt(0)
    s_barrier
    ds_write_b128 v12, v[80:83] offset:0
    ds_write_b128 v12, v[84:87] offset:1024
    ds_write_b128 v12, v[88:91] offset:8192
    ds_write_b128 v12, v[92:95] offset:9216
    s_waitcnt lgkmcnt(0)
    s_barrier
    ds_write_b128 v12, v[96:99] offset:16384
    ds_write_b128 v12, v[100:103] offset:17408
    ds_write_b128 v12, v[104:107] offset:24576
    ds_write_b128 v12, v[108:111] offset:25600
    s_waitcnt lgkmcnt(0)
    s_barrier
    ds_write_b128 v13, v[112:115] offset:0
    ds_write_b128 v13, v[116:119] offset:1024
    ds_write_b128 v13, v[120:123] offset:8192
    ds_write_b128 v13, v[124:127] offset:9216
    v_lshrrev_b32 v140, 2, v142
    buffer_load_dword v141, v140, s[12:15], s36 offen sc1
    s_waitcnt vmcnt(0)
    v_cmp_ne_u32 vcc, s32, v141
    s_nop 3
    s_cbranch_vccz L_s5_ok
    s_mov_b32 s47, 0x40000
L_s5_spin:
    s_sleep 2
    v_lshrrev_b32 v140, 2, v142
    buffer_load_dword v141, v140, s[12:15], s36 offen sc1
    s_waitcnt vmcnt(0)
    v_cmp_ne_u32 vcc, s32, v141
    s_nop 3
    s_cbranch_vccz L_s5_ok
    s_sub_u32 s47, s47, 1
    s_cmp_lg_u32 s47, 0
    s_cbranch_scc1 L_s5_spin
L_s5_ok:
    s_waitcnt lgkmcnt(0)
    s_barrier
    ds_write_b128 v12, v[128:131] offset:0
    ds_write_b128 v12, v[132:135] offset:1024
    ds_write_b128 v12, a[0:3] offset:8192
    ds_write_b128 v12, a[4:7] offset:9216
    s_waitcnt lgkmcnt(0)
    s_barrier
    ds_write_b128 v12, a[8:11] offset:16384
    ds_write_b128 v12, a[12:15] offset:17408
    ds_write_b128 v12, a[16:19] offset:24576
    ds_write_b128 v12, a[20:23] offset:25600
    s_waitcnt lgkmcnt(0)
    s_barrier
    ds_write_b128 v13, a[24:27] offset:0
    ds_write_b128 v13, a[28:31] offset:1024
    ds_write_b128 v13, a[32:35] offset:8192
    ds_write_b128 v13, a[36:39] offset:9216
    s_waitcnt lgkmcnt(0)
    s_barrier
    ds_write_b128 v12, a[40:43] offset:0
    ds_write_b128 v12, a[44:47] offset:1024
    ds_write_b128 v12, a[48:51] offset:8192
    ds_write_b128 v12, a[52:55] offset:9216
    s_waitcnt lgkmcnt(0)
    s_barrier
    ds_write_b128 v12, a[56:59] offset:16384
    ds_write_b128 v12, a[60:63] offset:17408
    ds_write_b128 v12, a[64:67] offset:24576
    ds_write_b128 v12, a[68:71] offset:25600
    s_waitcnt lgkmcnt(0)
    s_barrier
    ds_write_b128 v13, a[72:75] offset:0
    ds_write_b128 v13, a[76:79] offset:1024
    ds_write_b128 v13, a[80:83] offset:8192
    ds_write_b128 v13, a[84:87] offset:9216
    s_waitcnt lgkmcnt(0)
    s_barrier
    ds_write_b128 v12, a[88:91] offset:0
    ds_write_b128 v12, a[92:95] offset:1024
    ds_write_b128 v12, a[96:99] offset:8192
    ds_write_b128 v12, a[100:103] offset:9216
    s_waitcnt lgkmcnt(0)
    s_barrier
    ds_write_b128 v12, a[104:107] offset:16384
    ds_write_b128 v12, a[108:111] offset:17408
    ds_write_b128 v12, v[0:3] offset:24576
    ds_write_b128 v12, v[4:7] offset:25600
    s_waitcnt lgkmcnt(0)
    s_barrier
    ds_write_b128 v13, v[16:19] offset:0
    ds_write_b128 v13, v[20:23] offset:1024
    ds_write_b128 v13, v[24:27] offset:8192
    ds_write_b128 v13, v[28:31] offset:9216
    s_waitcnt lgkmcnt(0)
    s_barrier
    s_endpgm
L_C:
    s_lshr_b32 s21, s20, 1
    s_and_b32 s22, s20, 1
    v_and_b32 v104, 15, v143
    s_lshl_b32 s38, s21, 13
    v_lshlrev_b32 v105, 7, v104
    v_add_u32 v105, s38, v105
    v_lshrrev_b32 v106, 4, v143
    v_lshrrev_b32 v107, 1, v104
    v_xor_b32 v107, v107, v106
    v_lshl_add_u32 v96, v107, 4, v105
    v_xor_b32 v97, 64, v96
    v_and_b32 v105, 1, v106
    v_lshlrev_b32 v105, 10, v105
    v_lshrrev_b32 v107, 1, v106
    v_lshl_add_u32 v105, v107, 9, v105
    v_lshl_add_u32 v136, v104, 4, v105
    v_bfe_u32 v107, v104, 2, 1
    v_lshl_add_u32 v105, v107, 8, v105
    v_lshrrev_b32 v107, 3, v104
    v_lshl_add_u32 v105, v107, 6, v105
    v_and_b32 v107, 3, v104
    v_lshl_add_u32 v103, v107, 4, v105
    v_bfe_u32 v104, v143, 2, 2
    v_lshl_add_u32 v105, v106, 3, v104
    v_mul_u32_u24 v105, 384, v105
    v_lshrrev_b32 v104, 1, v104
    v_xor_b32 v104, s22, v104
    v_lshl_add_u32 v105, v104, 6, v105
    v_and_b32 v104, 1, v106
    v_lshl_add_u32 v105, v104, 5, v105
    v_and_b32 v104, 3, v143
    v_lshl_add_u32 v98, v104, 3, v105
    v_xor_b32 v99, 32, v98
    v_mov_b32 v102, v99
    s_mov_b32 s31, 0
    s_mov_b32 s25, 0
    v_mov_b32 v101, v98
    v_mov_b32 v100, v96
    s_waitcnt lgkmcnt(0)
    s_mov_b32 s12, s66
    s_mov_b32 s13, s67
    s_lshl_b32 s97, s24, 7
    s_lshl_b32 s38, s23, 3
    s_add_u32 s97, s97, s38
    s_and_b32 s38, s20, 3
    s_lshl_b32 s38, s38, 1
    s_add_u32 s97, s97, s38
    s_lshl_b32 s38, s97, 11
    s_mov_b32 s4, s48
    s_mov_b32 s5, s49
    s_mov_b32 s16, s60
    s_mov_b32 s17, s61
    s_mov_b32 s18, 2048
    buffer_load_dwordx4 v[0:3], v142, s[4:7], s38 offen offset:0
    buffer_load_dwordx4 v[4:7], v142, s[4:7], s38 offen offset:1024
    buffer_load_dwordx4 v[8:11], v142, s[4:7], s38 offen offset:2048
    buffer_load_dwordx4 v[12:15], v142, s[4:7], s38 offen offset:3072
    buffer_load_dwordx4 v[16:19], v142, s[16:19], 0 offen offset:0
    buffer_load_dwordx4 v[20:23], v142, s[16:19], 0 offen offset:1024
    s_lshl_b32 s91, s23, 8
    s_lshl_b32 s38, s24, 4
    s_add_u32 s91, s91, s38
    s_lshl_b32 s38, s20, 2
    s_add_u32 s91, s91, s38
    s_add_u32 s91, s91, 34603008
    s_lshl_b32 s98, s24, 8
    s_lshl_b32 s37, s23, 4
    s_add_u32 s98, s98, s37
    s_add_u32 s98, s98, s38
    s_add_u32 s98, s98, 34611200
    s_lshl_b32 s94, s24, 2
    s_lshl_b32 s36, s21, 1
    s_add_u32 s94, s94, s36
    s_lshl_b32 s95, s23, 1
    s_add_u32 s95, s95, s22
    s_mov_b32 s44, 0x3e8293ee
    s_mov_b32 s45, s44
    s_add_u32 s34, s23, 5
    s_and_b32 s34, s34, 15
    s_lshl_b32 s34, s34, 1
    s_add_u32 s34, s34, s22
    s_lshl_b32 s34, s34, 6
    s_add_u32 s34, s34, s94
    s_lshl_b32 s34, s34, 12
    s_add_u32 s34, s34, 1048576
    s_add_u32 s42, s23, 10
    s_and_b32 s42, s42, 15
    s_lshl_b32 s42, s42, 1
    s_add_u32 s42, s42, s22
    s_lshl_b32 s42, s42, 6
    s_add_u32 s42, s42, s94
    s_lshl_b32 s42, s42, 12
    s_add_u32 s42, s42, 1050624
    s_add_u32 s35, s34, 4096
    s_add_u32 s43, s42, 4096
    v_mov_b32 v48, 0
    v_mov_b32 v49, 0
    v_mov_b32 v50, 0
    v_mov_b32 v51, 0
    v_mov_b32 v52, 0
    v_mov_b32 v53, 0
    v_mov_b32 v54, 0
    v_mov_b32 v55, 0
    v_mov_b32 v56, 0
    v_mov_b32 v57, 0
    v_mov_b32 v58, 0
    v_mov_b32 v59, 0
    v_mov_b32 v60, 0
    v_mov_b32 v61, 0
    v_mov_b32 v62, 0
    v_mov_b32 v63, 0
    v_mov_b32 v64, 0
    v_mov_b32 v65, 0
    v_mov_b32 v66, 0
    v_mov_b32 v67, 0
    v_mov_b32 v68, 0
    v_mov_b32 v69, 0
    v_mov_b32 v70, 0
    v_mov_b32 v71, 0
    v_mov_b32 v72, 0
    v_mov_b32 v73, 0
    v_mov_b32 v74, 0
    v_mov_b32 v75, 0
    v_mov_b32 v76, 0
    v_mov_b32 v77, 0
    v_mov_b32 v78, 0
    v_mov_b32 v79, 0
    v_mov_b32 v80, 0
    v_mov_b32 v81, 0
    v_mov_b32 v82, 0
    v_mov_b32 v83, 0
    v_mov_b32 v84, 0
    v_mov_b32 v85, 0
    v_mov_b32 v86, 0
    v_mov_b32 v87, 0
    v_mov_b32 v88, 0
    v_mov_b32 v89, 0
    v_mov_b32 v90, 0
    v_mov_b32 v91, 0
    v_mov_b32 v92, 0
    v_mov_b32 v93, 0
    v_mov_b32 v94, 0
    v_mov_b32 v95, 0
    s_waitcnt vmcnt(0)
    s_mov_b32 s46, 0xffff0000
    s_mov_b32 s99, 0x3f803f80
    v_mov_b32 v32, 0
    v_mov_b32 v33, 0
    v_lshlrev_b32 v24, 16, v16
    v_and_b32 v25, s46, v16
    v_lshlrev_b32 v26, 16, v0
    v_and_b32 v27, s46, v0
    v_pk_mul_f32 v[26:27], v[26:27], v[24:25]
    v_cvt_pk_bf16_f32 v30, v26, v27
    v_dot2_f32_bf16 v32, v30, s99, v32
    v_lshlrev_b32 v28, 16, v8
    v_and_b32 v29, s46, v8
    v_pk_mul_f32 v[28:29], v[28:29], v[24:25]
    v_cvt_pk_bf16_f32 v31, v28, v29
    v_dot2_f32_bf16 v33, v31, s99, v33
    v_lshlrev_b32 v24, 16, v17
    v_and_b32 v25, s46, v17
    v_lshlrev_b32 v26, 16, v1
    v_and_b32 v27, s46, v1
    v_pk_mul_f32 v[26:27], v[26:27], v[24:25]
    v_cvt_pk_bf16_f32 v30, v26, v27
    v_dot2_f32_bf16 v32, v30, s99, v32
    v_lshlrev_b32 v28, 16, v9
    v_and_b32 v29, s46, v9
    v_pk_mul_f32 v[28:29], v[28:29], v[24:25]
    v_cvt_pk_bf16_f32 v31, v28, v29
    v_dot2_f32_bf16 v33, v31, s99, v33
    v_lshlrev_b32 v24, 16, v18
    v_and_b32 v25, s46, v18
    v_lshlrev_b32 v26, 16, v2
    v_and_b32 v27, s46, v2
    v_pk_mul_f32 v[26:27], v[26:27], v[24:25]
    v_cvt_pk_bf16_f32 v30, v26, v27
    v_dot2_f32_bf16 v32, v30, s99, v32
    v_lshlrev_b32 v28, 16, v10
    v_and_b32 v29, s46, v10
    v_pk_mul_f32 v[28:29], v[28:29], v[24:25]
    v_cvt_pk_bf16_f32 v31, v28, v29
    v_dot2_f32_bf16 v33, v31, s99, v33
    v_lshlrev_b32 v24, 16, v19
    v_and_b32 v25, s46, v19
    v_lshlrev_b32 v26, 16, v3
    v_and_b32 v27, s46, v3
    v_pk_mul_f32 v[26:27], v[26:27], v[24:25]
    v_cvt_pk_bf16_f32 v30, v26, v27
    v_dot2_f32_bf16 v32, v30, s99, v32
    v_lshlrev_b32 v28, 16, v11
    v_and_b32 v29, s46, v11
    v_pk_mul_f32 v[28:29], v[28:29], v[24:25]
    v_cvt_pk_bf16_f32 v31, v28, v29
    v_dot2_f32_bf16 v33, v31, s99, v33
    v_lshlrev_b32 v24, 16, v20
    v_and_b32 v25, s46, v20
    v_lshlrev_b32 v26, 16, v4
    v_and_b32 v27, s46, v4
    v_pk_mul_f32 v[26:27], v[26:27], v[24:25]
    v_cvt_pk_bf16_f32 v30, v26, v27
    v_dot2_f32_bf16 v32, v30, s99, v32
    v_lshlrev_b32 v28, 16, v12
    v_and_b32 v29, s46, v12
    v_pk_mul_f32 v[28:29], v[28:29], v[24:25]
    v_cvt_pk_bf16_f32 v31, v28, v29
    v_dot2_f32_bf16 v33, v31, s99, v33
    v_lshlrev_b32 v24, 16, v21
    v_and_b32 v25, s46, v21
    v_lshlrev_b32 v26, 16, v5
    v_and_b32 v27, s46, v5
    v_pk_mul_f32 v[26:27], v[26:27], v[24:25]
    v_cvt_pk_bf16_f32 v30, v26, v27
    v_dot2_f32_bf16 v32, v30, s99, v32
    v_lshlrev_b32 v28, 16, v13
    v_and_b32 v29, s46, v13
    v_pk_mul_f32 v[28:29], v[28:29], v[24:25]
    v_cvt_pk_bf16_f32 v31, v28, v29
    v_dot2_f32_bf16 v33, v31, s99, v33
    v_lshlrev_b32 v24, 16, v22
    v_and_b32 v25, s46, v22
    v_lshlrev_b32 v26, 16, v6
    v_and_b32 v27, s46, v6
    v_pk_mul_f32 v[26:27], v[26:27], v[24:25]
    v_cvt_pk_bf16_f32 v30, v26, v27
    v_dot2_f32_bf16 v32, v30, s99, v32
    v_lshlrev_b32 v28, 16, v14
    v_and_b32 v29, s46, v14
    v_pk_mul_f32 v[28:29], v[28:29], v[24:25]
    v_cvt_pk_bf16_f32 v31, v28, v29
    v_dot2_f32_bf16 v33, v31, s99, v33
    v_lshlrev_b32 v24, 16, v23
    v_and_b32 v25, s46, v23
    v_lshlrev_b32 v26, 16, v7
    v_and_b32 v27, s46, v7
    v_pk_mul_f32 v[26:27], v[26:27], v[24:25]
    v_cvt_pk_bf16_f32 v30, v26, v27
    v_dot2_f32_bf16 v32, v30, s99, v32
    v_lshlrev_b32 v28, 16, v15
    v_and_b32 v29, s46, v15
    v_pk_mul_f32 v[28:29], v[28:29], v[24:25]
    v_cvt_pk_bf16_f32 v31, v28, v29
    v_dot2_f32_bf16 v33, v31, s99, v33
    s_nop 2
    s_nop 1
    v_add_f32_dpp v32, v32, v32 row_shr:1 row_mask:0xf bank_mask:0xf bound_ctrl:0
    v_add_f32_dpp v33, v33, v33 row_shr:1 row_mask:0xf bank_mask:0xf bound_ctrl:0
    s_nop 1
    v_add_f32_dpp v32, v32, v32 row_shr:2 row_mask:0xf bank_mask:0xf bound_ctrl:0
    v_add_f32_dpp v33, v33, v33 row_shr:2 row_mask:0xf bank_mask:0xf bound_ctrl:0
    s_nop 1
    v_add_f32_dpp v32, v32, v32 row_shr:4 row_mask:0xf bank_mask:0xf bound_ctrl:0
    v_add_f32_dpp v33, v33, v33 row_shr:4 row_mask:0xf bank_mask:0xf bound_ctrl:0
    s_nop 1
    v_add_f32_dpp v32, v32, v32 row_shr:8 row_mask:0xf bank_mask:0xf bound_ctrl:0
    v_add_f32_dpp v33, v33, v33 row_shr:8 row_mask:0xf bank_mask:0xf bound_ctrl:0
    s_nop 1
    v_add_f32_dpp v32, v32, v32 row_bcast:15 row_mask:0xa bank_mask:0xf
    v_add_f32_dpp v33, v33, v33 row_bcast:15 row_mask:0xa bank_mask:0xf
    s_nop 1
    v_add_f32_dpp v32, v32, v32 row_bcast:31 row_mask:0xc bank_mask:0xf
    v_add_f32_dpp v33, v33, v33 row_bcast:31 row_mask:0xc bank_mask:0xf
    v_cmp_gt_u32 vcc, 63, v143
    v_mov_b32 v44, 0x7f000000
    s_lshl_b32 s97, s97, 3
    s_add_u32 s97, s97, 33554432
    v_cndmask_b32 v44, 0, v44, vcc
    v_cvt_pk_bf16_f32 v24, v32, v33
    v_lshlrev_b32 v26, 16, v24
    v_and_b32 v27, s46, v24
    v_mul_f32 v26, 0xbfb8aa3b, v26
    v_mul_f32 v27, 0xbfb8aa3b, v27
    v_exp_f32 v26, v26
    v_exp_f32 v27, v27
    s_nop 0
    v_add_f32 v26, 1.0, v26
    v_add_f32 v27, 1.0, v27
    v_rcp_f32 v26, v26
    v_rcp_f32 v27, v27
    s_nop 0
    v_cvt_pk_bf16_f32 v24, v26, v27
    v_lshlrev_b32 v36, 16, v24
    v_and_b32 v38, s46, v24
    v_sub_f32 v26, 1.0, v36
    v_sub_f32 v27, 1.0, v38
    v_cvt_pk_bf16_f32 v24, v26, v27
    v_lshlrev_b32 v37, 16, v24
    v_and_b32 v39, s46, v24
    buffer_store_dwordx4 v[36:39], v44, s[12:15], s97 offen sc1
    v_mov_b32 v0, 0
    v_mov_b32 v1, 0
    v_mov_b32 v2, 0
    v_mov_b32 v3, 0
    v_mov_b32 v4, 0
    v_mov_b32 v5, 0
    v_mov_b32 v6, 0
    v_mov_b32 v7, 0
    v_mov_b32 v8, 0
    v_mov_b32 v9, 0
    v_mov_b32 v10, 0
    v_mov_b32 v11, 0
    v_mov_b32 v12, 0
    v_mov_b32 v13, 0
    v_mov_b32 v14, 0
    v_mov_b32 v15, 0
    v_mov_b32 v16, 0
    v_mov_b32 v17, 0
    v_mov_b32 v18, 0
    v_mov_b32 v19, 0
    v_mov_b32 v20, 0
    v_mov_b32 v21, 0
    v_mov_b32 v22, 0
    v_mov_b32 v23, 0
    v_mov_b32 v24, 0
    v_mov_b32 v25, 0
    v_mov_b32 v26, 0
    v_mov_b32 v27, 0
    v_mov_b32 v28, 0
    v_mov_b32 v29, 0
    v_mov_b32 v30, 0
    v_mov_b32 v31, 0
    v_mov_b32 v32, 0
    v_mov_b32 v33, 0
    v_mov_b32 v34, 0
    v_mov_b32 v35, 0
    v_mov_b32 v36, 0
    v_mov_b32 v37, 0
    v_mov_b32 v38, 0
    v_mov_b32 v39, 0
    v_mov_b32 v40, 0
    v_mov_b32 v41, 0
    v_mov_b32 v42, 0
    v_mov_b32 v43, 0
    v_mov_b32 v44, 0
    v_mov_b32 v45, 0
    v_mov_b32 v46, 0
    v_mov_b32 v47, 0
    s_barrier
    ds_read_b128 a[0:3], v100 offset:0
    ds_read_b128 a[4:7], v100 offset:2048
    ds_read_b128 a[8:11], v100 offset:4096
    ds_read_b128 a[12:15], v100 offset:6144
    ds_read_b64_tr_b16 a[16:17], v101 offset:16384
    ds_read_b64_tr_b16 a[18:19], v101 offset:17920
    ds_read_b64_tr_b16 a[20:21], v102 offset:16384
    ds_read_b64_tr_b16 a[22:23], v102 offset:17920
    ds_read_b64_tr_b16 a[24:25], v101 offset:16512
    ds_read_b64_tr_b16 a[26:27], v101 offset:18048
    ds_read_b64_tr_b16 a[28:29], v102 offset:16512
    ds_read_b64_tr_b16 a[30:31], v102 offset:18048
    ds_read_b64_tr_b16 a[32:33], v101 offset:16640
    ds_read_b64_tr_b16 a[34:35], v101 offset:18176
    ds_read_b64_tr_b16 a[36:37], v102 offset:16640
    ds_read_b64_tr_b16 a[38:39], v102 offset:18176
    v_mov_b32 v100, v97
    s_mov_b32 s33, 99
L_g:
    s_waitcnt lgkmcnt(0)
    v_mfma_f32_16x16x32_bf16 v[0:3], a[16:19], a[0:3], v[0:3]
    ds_read_b128 a[40:43], v100 offset:0
    v_mfma_f32_16x16x32_bf16 v[4:7], a[16:19], a[4:7], v[4:7]
    ds_read_b128 a[44:47], v100 offset:2048
    v_mfma_f32_16x16x32_bf16 v[8:11], a[16:19], a[8:11], v[8:11]
    ds_read_b128 a[48:51], v100 offset:4096
    v_mfma_f32_16x16x32_bf16 v[12:15], a[16:19], a[12:15], v[12:15]
    ds_read_b128 a[52:55], v100 offset:6144
    v_mfma_f32_16x16x32_bf16 v[16:19], a[20:23], a[0:3], v[16:19]
    ds_read_b64_tr_b16 a[56:57], v101 offset:28672
    v_mfma_f32_16x16x32_bf16 v[20:23], a[20:23], a[4:7], v[20:23]
    ds_read_b64_tr_b16 a[58:59], v101 offset:30208
    v_mfma_f32_16x16x32_bf16 v[24:27], a[20:23], a[8:11], v[24:27]
    ds_read_b64_tr_b16 a[60:61], v102 offset:28672
    v_mfma_f32_16x16x32_bf16 v[28:31], a[20:23], a[12:15], v[28:31]
    ds_read_b64_tr_b16 a[62:63], v102 offset:30208
    v_mfma_f32_16x16x32_bf16 v[32:35], a[24:27], a[0:3], v[32:35]
    ds_read_b64_tr_b16 a[64:65], v101 offset:28800
    v_mfma_f32_16x16x32_bf16 v[36:39], a[24:27], a[4:7], v[36:39]
    ds_read_b64_tr_b16 a[66:67], v101 offset:30336
    v_mfma_f32_16x16x32_bf16 v[40:43], a[24:27], a[8:11], v[40:43]
    ds_read_b64_tr_b16 a[68:69], v102 offset:28800
    v_mfma_f32_16x16x32_bf16 v[44:47], a[24:27], a[12:15], v[44:47]
    ds_read_b64_tr_b16 a[70:71], v102 offset:30336
    v_mfma_f32_16x16x32_bf16 v[48:51], a[28:31], a[0:3], v[48:51]
    ds_read_b64_tr_b16 a[72:73], v101 offset:28928
    v_mfma_f32_16x16x32_bf16 v[52:55], a[28:31], a[4:7], v[52:55]
    ds_read_b64_tr_b16 a[74:75], v101 offset:30464
    v_mfma_f32_16x16x32_bf16 v[56:59], a[28:31], a[8:11], v[56:59]
    ds_read_b64_tr_b16 a[76:77], v102 offset:28928
    v_mfma_f32_16x16x32_bf16 v[60:63], a[28:31], a[12:15], v[60:63]
    ds_read_b64_tr_b16 a[78:79], v102 offset:30464
    v_mfma_f32_16x16x32_bf16 v[64:67], a[0:3], a[32:35], v[64:67]
    v_mfma_f32_16x16x32_bf16 v[68:71], a[4:7], a[32:35], v[68:71]
    v_mfma_f32_16x16x32_bf16 v[72:75], a[8:11], a[32:35], v[72:75]
    s_add_u32 s31, s31, 40960
    s_cmp_ge_u32 s31, 163840
    v_mfma_f32_16x16x32_bf16 v[76:79], a[12:15], a[32:35], v[76:79]
    s_cselect_b32 s31, 0, s31
    v_mfma_f32_16x16x32_bf16 v[80:83], a[0:3], a[36:39], v[80:83]
    v_mfma_f32_16x16x32_bf16 v[84:87], a[4:7], a[36:39], v[84:87]
    v_mfma_f32_16x16x32_bf16 v[88:91], a[8:11], a[36:39], v[88:91]
    v_mfma_f32_16x16x32_bf16 v[92:95], a[12:15], a[36:39], v[92:95]
L_g1:
    s_cmp_eq_u32 s25, s33
    s_cbranch_scc1 L_hook
L_g1r:
    v_add_u32 v101, s31, v98
    v_add_u32 v102, s31, v99
    v_add_u32 v100, s31, v96
    s_waitcnt lgkmcnt(0)
    s_barrier
    v_mfma_f32_16x16x32_bf16 v[0:3], a[56:59], a[40:43], v[0:3]
    ds_read_b128 a[0:3], v100 offset:0
    v_mfma_f32_16x16x32_bf16 v[4:7], a[56:59], a[44:47], v[4:7]
    ds_read_b128 a[4:7], v100 offset:2048
    v_mfma_f32_16x16x32_bf16 v[8:11], a[56:59], a[48:51], v[8:11]
    ds_read_b128 a[8:11], v100 offset:4096
    v_mfma_f32_16x16x32_bf16 v[12:15], a[56:59], a[52:55], v[12:15]
    ds_read_b128 a[12:15], v100 offset:6144
    v_mfma_f32_16x16x32_bf16 v[16:19], a[60:63], a[40:43], v[16:19]
    ds_read_b64_tr_b16 a[16:17], v101 offset:16384
    v_mfma_f32_16x16x32_bf16 v[20:23], a[60:63], a[44:47], v[20:23]
    ds_read_b64_tr_b16 a[18:19], v101 offset:17920
    v_mfma_f32_16x16x32_bf16 v[24:27], a[60:63], a[48:51], v[24:27]
    ds_read_b64_tr_b16 a[20:21], v102 offset:16384
    v_mfma_f32_16x16x32_bf16 v[28:31], a[60:63], a[52:55], v[28:31]
    ds_read_b64_tr_b16 a[22:23], v102 offset:17920
    v_mfma_f32_16x16x32_bf16 v[32:35], a[64:67], a[40:43], v[32:35]
    ds_read_b64_tr_b16 a[24:25], v101 offset:16512
    v_mfma_f32_16x16x32_bf16 v[36:39], a[64:67], a[44:47], v[36:39]
    ds_read_b64_tr_b16 a[26:27], v101 offset:18048
    v_mfma_f32_16x16x32_bf16 v[40:43], a[64:67], a[48:51], v[40:43]
    ds_read_b64_tr_b16 a[28:29], v102 offset:16512
    v_mfma_f32_16x16x32_bf16 v[44:47], a[64:67], a[52:55], v[44:47]
    ds_read_b64_tr_b16 a[30:31], v102 offset:18048
    v_mfma_f32_16x16x32_bf16 v[48:51], a[68:71], a[40:43], v[48:51]
    ds_read_b64_tr_b16 a[32:33], v101 offset:16640
    v_mfma_f32_16x16x32_bf16 v[52:55], a[68:71], a[44:47], v[52:55]
    ds_read_b64_tr_b16 a[34:35], v101 offset:18176
    v_mfma_f32_16x16x32_bf16 v[56:59], a[68:71], a[48:51], v[56:59]
    ds_read_b64_tr_b16 a[36:37], v102 offset:16640
    v_mfma_f32_16x16x32_bf16 v[60:63], a[68:71], a[52:55], v[60:63]
    ds_read_b64_tr_b16 a[38:39], v102 offset:18176
    v_mfma_f32_16x16x32_bf16 v[64:67], a[40:43], a[72:75], v[64:67]
    v_mfma_f32_16x16x32_bf16 v[68:71], a[44:47], a[72:75], v[68:71]
    v_xor_b32 v100, 64, v100
    v_mfma_f32_16x16x32_bf16 v[72:75], a[48:51], a[72:75], v[72:75]
    v_mfma_f32_16x16x32_bf16 v[76:79], a[52:55], a[72:75], v[76:79]
    s_add_u32 s25, s25, 1
    s_and_b32 s36, s25, 15
    v_mfma_f32_16x16x32_bf16 v[80:83], a[40:43], a[76:79], v[80:83]
    s_cmp_lg_u32 s36, 0
    v_mfma_f32_16x16x32_bf16 v[84:87], a[44:47], a[76:79], v[84:87]
    v_mfma_f32_16x16x32_bf16 v[88:91], a[48:51], a[76:79], v[88:91]
    v_mfma_f32_16x16x32_bf16 v[92:95], a[52:55], a[76:79], v[92:95]
    s_cbranch_scc1 L_g
    s_cmp_eq_u32 s25, 32
    s_cbranch_scc1 L_gend
    s_mov_b32 s33, 16
    s_add_u32 s31, s31, 40960
    s_cmp_ge_u32 s31, 163840
    s_cselect_b32 s31, 0, s31
    s_waitcnt lgkmcnt(0)
    v_pk_mul_f32 v[0:1], v[0:1], s[44:45]
    v_pk_mul_f32 v[2:3], v[2:3], s[44:45]
    v_pk_mul_f32 v[16:17], v[16:17], s[44:45]
    v_pk_mul_f32 v[18:19], v[18:19], s[44:45]
    v_cvt_pk_bf16_f32 v104, v0, v1
    v_cvt_pk_bf16_f32 v105, v2, v3
    v_cvt_pk_bf16_f32 v106, v16, v17
    v_cvt_pk_bf16_f32 v107, v18, v19
    v_mfma_f32_16x16x32_bf16 v[0:3], a[16:19], a[0:3], 0
    v_mfma_f32_16x16x32_bf16 v[16:19], a[20:23], a[0:3], 0
    ds_read_b128 a[40:43], v100 offset:0
    ds_read_b128 a[44:47], v100 offset:2048
    v_pk_mul_f32 v[4:5], v[4:5], s[44:45]
    v_pk_mul_f32 v[6:7], v[6:7], s[44:45]
    v_pk_mul_f32 v[20:21], v[20:21], s[44:45]
    v_pk_mul_f32 v[22:23], v[22:23], s[44:45]
    v_cvt_pk_bf16_f32 v108, v4, v5
    v_cvt_pk_bf16_f32 v109, v6, v7
    v_cvt_pk_bf16_f32 v110, v20, v21
    v_cvt_pk_bf16_f32 v111, v22, v23
    v_mfma_f32_16x16x32_bf16 v[4:7], a[16:19], a[4:7], 0
    v_mfma_f32_16x16x32_bf16 v[20:23], a[20:23], a[4:7], 0
    v_permlane16_swap_b32 v104, v108
    v_permlane16_swap_b32 v105, v109
    v_permlane16_swap_b32 v106, v110
    v_permlane16_swap_b32 v107, v111
    v_accvgpr_write_b32 a80, v104
    v_accvgpr_write_b32 a81, v105
    v_accvgpr_write_b32 a82, v106
    v_accvgpr_write_b32 a83, v107
    v_accvgpr_write_b32 a84, v108
    v_accvgpr_write_b32 a85, v109
    v_accvgpr_write_b32 a86, v110
    v_accvgpr_write_b32 a87, v111
    ds_read_b128 a[48:51], v100 offset:4096
    ds_read_b128 a[52:55], v100 offset:6144
    v_pk_mul_f32 v[8:9], v[8:9], s[44:45]
    v_pk_mul_f32 v[10:11], v[10:11], s[44:45]
    v_pk_mul_f32 v[24:25], v[24:25], s[44:45]
    v_pk_mul_f32 v[26:27], v[26:27], s[44:45]
    v_cvt_pk_bf16_f32 v112, v8, v9
    v_cvt_pk_bf16_f32 v113, v10, v11
    v_cvt_pk_bf16_f32 v114, v24, v25
    v_cvt_pk_bf16_f32 v115, v26, v27
    v_mfma_f32_16x16x32_bf16 v[8:11], a[16:19], a[8:11], 0
    v_mfma_f32_16x16x32_bf16 v[24:27], a[20:23], a[8:11], 0
    ds_read_b64_tr_b16 a[56:57], v101 offset:28672
    ds_read_b64_tr_b16 a[58:59], v101 offset:30208
    v_pk_mul_f32 v[12:13], v[12:13], s[44:45]
    v_pk_mul_f32 v[14:15], v[14:15], s[44:45]
    v_pk_mul_f32 v[28:29], v[28:29], s[44:45]
    v_pk_mul_f32 v[30:31], v[30:31], s[44:45]
    v_cvt_pk_bf16_f32 v116, v12, v13
    v_cvt_pk_bf16_f32 v117, v14, v15
    v_cvt_pk_bf16_f32 v118, v28, v29
    v_cvt_pk_bf16_f32 v119, v30, v31
    v_mfma_f32_16x16x32_bf16 v[12:15], a[16:19], a[12:15], 0
    v_mfma_f32_16x16x32_bf16 v[28:31], a[20:23], a[12:15], 0
    v_permlane16_swap_b32 v112, v116
    v_permlane16_swap_b32 v113, v117
    v_permlane16_swap_b32 v114, v118
    v_permlane16_swap_b32 v115, v119
    v_accvgpr_write_b32 a88, v112
    v_accvgpr_write_b32 a89, v113
    v_accvgpr_write_b32 a90, v114
    v_accvgpr_write_b32 a91, v115
    v_accvgpr_write_b32 a92, v116
    v_accvgpr_write_b32 a93, v117
    v_accvgpr_write_b32 a94, v118
    v_accvgpr_write_b32 a95, v119
    ds_read_b64_tr_b16 a[60:61], v102 offset:28672
    ds_read_b64_tr_b16 a[62:63], v102 offset:30208
    v_cvt_pk_bf16_f32 v120, v32, v33
    v_cvt_pk_bf16_f32 v121, v34, v35
    v_cvt_pk_bf16_f32 v122, v48, v49
    v_cvt_pk_bf16_f32 v123, v50, v51
    v_mfma_f32_16x16x32_bf16 v[32:35], a[24:27], a[0:3], 0
    v_mfma_f32_16x16x32_bf16 v[48:51], a[28:31], a[0:3], 0
    ds_read_b64_tr_b16 a[64:65], v101 offset:28800
    ds_read_b64_tr_b16 a[66:67], v101 offset:30336
    v_cvt_pk_bf16_f32 v124, v36, v37
    v_cvt_pk_bf16_f32 v125, v38, v39
    v_cvt_pk_bf16_f32 v126, v52, v53
    v_cvt_pk_bf16_f32 v127, v54, v55
    v_mfma_f32_16x16x32_bf16 v[36:39], a[24:27], a[4:7], 0
    v_mfma_f32_16x16x32_bf16 v[52:55], a[28:31], a[4:7], 0
    ds_read_b64_tr_b16 a[68:69], v102 offset:28800
    ds_read_b64_tr_b16 a[70:71], v102 offset:30336
    v_cvt_pk_bf16_f32 v128, v40, v41
    v_cvt_pk_bf16_f32 v129, v42, v43
    v_cvt_pk_bf16_f32 v130, v56, v57
    v_cvt_pk_bf16_f32 v131, v58, v59
    v_mfma_f32_16x16x32_bf16 v[40:43], a[24:27], a[8:11], 0
    v_mfma_f32_16x16x32_bf16 v[56:59], a[28:31], a[8:11], 0
    ds_read_b64_tr_b16 a[72:73], v101 offset:28928
    ds_read_b64_tr_b16 a[74:75], v101 offset:30464
    v_cvt_pk_bf16_f32 v132, v44, v45
    v_cvt_pk_bf16_f32 v133, v46, v47
    v_cvt_pk_bf16_f32 v134, v60, v61
    v_cvt_pk_bf16_f32 v135, v62, v63
    v_mfma_f32_16x16x32_bf16 v[44:47], a[24:27], a[12:15], 0
    v_mfma_f32_16x16x32_bf16 v[60:63], a[28:31], a[12:15], 0
    ds_read_b64_tr_b16 a[76:77], v102 offset:28928
    ds_read_b64_tr_b16 a[78:79], v102 offset:30464
    v_cvt_pk_bf16_f32 v104, v64, v65
    v_cvt_pk_bf16_f32 v105, v66, v67
    v_cvt_pk_bf16_f32 v106, v68, v69
    v_cvt_pk_bf16_f32 v107, v70, v71
    v_mfma_f32_16x16x32_bf16 v[64:67], a[0:3], a[32:35], 0
    v_mfma_f32_16x16x32_bf16 v[68:71], a[4:7], a[32:35], 0
    v_cvt_pk_bf16_f32 v108, v72, v73
    v_cvt_pk_bf16_f32 v109, v74, v75
    v_cvt_pk_bf16_f32 v110, v76, v77
    v_cvt_pk_bf16_f32 v111, v78, v79
    v_mfma_f32_16x16x32_bf16 v[72:75], a[8:11], a[32:35], 0
    v_mfma_f32_16x16x32_bf16 v[76:79], a[12:15], a[32:35], 0
    v_cvt_pk_bf16_f32 v112, v80, v81
    v_cvt_pk_bf16_f32 v113, v82, v83
    v_cvt_pk_bf16_f32 v114, v84, v85
    v_cvt_pk_bf16_f32 v115, v86, v87
    v_mfma_f32_16x16x32_bf16 v[80:83], a[0:3], a[36:39], 0
    v_mfma_f32_16x16x32_bf16 v[84:87], a[4:7], a[36:39], 0
    v_cvt_pk_bf16_f32 v116, v88, v89
    v_cvt_pk_bf16_f32 v117, v90, v91
    v_cvt_pk_bf16_f32 v118, v92, v93
    v_cvt_pk_bf16_f32 v119, v94, v95
    v_mfma_f32_16x16x32_bf16 v[88:91], a[8:11], a[36:39], 0
    v_mfma_f32_16x16x32_bf16 v[92:95], a[12:15], a[36:39], 0
    buffer_store_dwordx4 v[120:123], v103, s[12:15], s34 offen offset:0 sc1
    buffer_store_dwordx4 v[124:127], v103, s[12:15], s34 offen offset:128 sc1
    s_getpc_b64 s[28:29]
L_hk1_pc:
    s_add_u32 s28, s28, L_hk1-L_hk1_pc
    s_addc_u32 s29, s29, 0
    s_mov_b32 s33, 17
    s_branch L_g1r
L_hk1:
    buffer_store_dwordx4 v[128:131], v103, s[12:15], s35 offen offset:0 sc1
    buffer_store_dwordx4 v[132:135], v103, s[12:15], s35 offen offset:128 sc1
    s_getpc_b64 s[28:29]
L_hk2_pc:
    s_add_u32 s28, s28, L_hk2-L_hk2_pc
    s_addc_u32 s29, s29, 0
    s_mov_b32 s33, 18
    s_branch L_g1r
L_hk2:
    buffer_store_dwordx4 v[104:107], v136, s[12:15], s42 offen offset:0 sc1
    buffer_store_dwordx4 v[108:111], v136, s[12:15], s43 offen offset:0 sc1
    s_getpc_b64 s[28:29]
L_hk3_pc:
    s_add_u32 s28, s28, L_hk3-L_hk3_pc
    s_addc_u32 s29, s29, 0
    s_mov_b32 s33, 19
    s_branch L_g1r
L_hk3:
    buffer_store_dwordx4 v[112:115], v136, s[12:15], s42 offen offset:256 sc1
    buffer_store_dwordx4 v[116:119], v136, s[12:15], s43 offen offset:256 sc1
    s_mov_b32 s16, s64
    s_mov_b32 s17, s65
    s_mov_b32 s18, 256
    v_mov_b32 v140, 0
    buffer_load_dword v141, v140, s[16:19], 0 offen sc1
    s_add_u32 s34, s34, 8388608
    s_add_u32 s35, s35, 8388608
    s_add_u32 s42, s42, 8388608
    s_add_u32 s43, s43, 8388608
    s_getpc_b64 s[28:29]
L_hkf_pc:
    s_add_u32 s28, s28, L_hkf-L_hkf_pc
    s_addc_u32 s29, s29, 0
    s_mov_b32 s33, 22
    s_branch L_g1r
L_hook:
    s_setpc_b64 s[28:29]
L_hkf:
    s_waitcnt vmcnt(0)
    v_readfirstlane_b32 s32, v141
    s_mov_b32 s33, 99
    s_nop 2
    s_cmp_lg_u32 s32, 0
    s_cbranch_scc0 L_Ctg
L_Ct_back:
    v_mov_b32 v139, s32
    v_min_u32 v140, 1, v143
    v_lshlrev_b32 v140, 30, v140
    buffer_store_dword v139, v140, s[12:15], s91 offen sc1
    s_branch L_g1r
L_Ctg:
    s_mov_b32 s16, s64
    s_mov_b32 s17, s65
    s_mov_b32 s18, 256
    s_mov_b32 s47, 0x40000
    v_mov_b32 v140, 0
L_Ct_l:
    buffer_load_dword v141, v140, s[16:19], 0 offen sc1
    s_waitcnt vmcnt(0)
    v_readfirstlane_b32 s32, v141
    s_nop 3
    s_cmp_lg_u32 s32, 0
    s_cbranch_scc1 L_Ct_ok
    s_sleep 2
    s_sub_u32 s47, s47, 1
    s_cmp_lg_u32 s47, 0
    s_cbranch_scc1 L_Ct_l
L_Ct_ok:
    s_branch L_Ct_back
L_gend:
    s_nop 4
    v_cvt_pk_bf16_f32 v120, v32, v33
    v_cvt_pk_bf16_f32 v121, v34, v35
    v_cvt_pk_bf16_f32 v122, v48, v49
    v_cvt_pk_bf16_f32 v123, v50, v51
    buffer_store_dwordx4 v[120:123], v103, s[12:15], s34 offen offset:0 sc1
    v_cvt_pk_bf16_f32 v124, v36, v37
    v_cvt_pk_bf16_f32 v125, v38, v39
    v_cvt_pk_bf16_f32 v126, v52, v53
    v_cvt_pk_bf16_f32 v127, v54, v55
    buffer_store_dwordx4 v[124:127], v103, s[12:15], s34 offen offset:128 sc1
    v_cvt_pk_bf16_f32 v128, v40, v41
    v_cvt_pk_bf16_f32 v129, v42, v43
    v_cvt_pk_bf16_f32 v130, v56, v57
    v_cvt_pk_bf16_f32 v131, v58, v59
    buffer_store_dwordx4 v[128:131], v103, s[12:15], s35 offen offset:0 sc1
    v_cvt_pk_bf16_f32 v132, v44, v45
    v_cvt_pk_bf16_f32 v133, v46, v47
    v_cvt_pk_bf16_f32 v134, v60, v61
    v_cvt_pk_bf16_f32 v135, v62, v63
    buffer_store_dwordx4 v[132:135], v103, s[12:15], s35 offen offset:128 sc1
    v_cvt_pk_bf16_f32 v104, v64, v65
    v_cvt_pk_bf16_f32 v105, v66, v67
    v_cvt_pk_bf16_f32 v106, v68, v69
    v_cvt_pk_bf16_f32 v107, v70, v71
    buffer_store_dwordx4 v[104:107], v136, s[12:15], s42 offen offset:0 sc1
    v_cvt_pk_bf16_f32 v108, v72, v73
    v_cvt_pk_bf16_f32 v109, v74, v75
    v_cvt_pk_bf16_f32 v110, v76, v77
    v_cvt_pk_bf16_f32 v111, v78, v79
    buffer_store_dwordx4 v[108:111], v136, s[12:15], s43 offen offset:0 sc1
    v_cvt_pk_bf16_f32 v112, v80, v81
    v_cvt_pk_bf16_f32 v113, v82, v83
    v_cvt_pk_bf16_f32 v114, v84, v85
    v_cvt_pk_bf16_f32 v115, v86, v87
    buffer_store_dwordx4 v[112:115], v136, s[12:15], s42 offen offset:256 sc1
    v_cvt_pk_bf16_f32 v116, v88, v89
    v_cvt_pk_bf16_f32 v117, v90, v91
    v_cvt_pk_bf16_f32 v118, v92, v93
    v_cvt_pk_bf16_f32 v119, v94, v95
    buffer_store_dwordx4 v[116:119], v136, s[12:15], s43 offen offset:256 sc1
    v_pk_mul_f32 v[0:1], v[0:1], s[44:45]
    v_pk_mul_f32 v[2:3], v[2:3], s[44:45]
    v_pk_mul_f32 v[16:17], v[16:17], s[44:45]
    v_pk_mul_f32 v[18:19], v[18:19], s[44:45]
    v_cvt_pk_bf16_f32 v32, v0, v1
    v_cvt_pk_bf16_f32 v33, v2, v3
    v_cvt_pk_bf16_f32 v34, v16, v17
    v_cvt_pk_bf16_f32 v35, v18, v19
    v_pk_mul_f32 v[4:5], v[4:5], s[44:45]
    v_pk_mul_f32 v[6:7], v[6:7], s[44:45]
    v_pk_mul_f32 v[20:21], v[20:21], s[44:45]
    v_pk_mul_f32 v[22:23], v[22:23], s[44:45]
    v_cvt_pk_bf16_f32 v36, v4, v5
    v_cvt_pk_bf16_f32 v37, v6, v7
    v_cvt_pk_bf16_f32 v38, v20, v21
    v_cvt_pk_bf16_f32 v39, v22, v23
    s_nop 1
    v_permlane16_swap_b32 v32, v36
    v_permlane16_swap_b32 v33, v37
    v_permlane16_swap_b32 v34, v38
    v_permlane16_swap_b32 v35, v39
    v_accvgpr_write_b32 a96, v32
    v_accvgpr_write_b32 a97, v33
    v_accvgpr_write_b32 a98, v34
    v_accvgpr_write_b32 a99, v35
    v_accvgpr_write_b32 a100, v36
    v_accvgpr_write_b32 a101, v37
    v_accvgpr_write_b32 a102, v38
    v_accvgpr_write_b32 a103, v39
    v_pk_mul_f32 v[8:9], v[8:9], s[44:45]
    v_pk_mul_f32 v[10:11], v[10:11], s[44:45]
    v_pk_mul_f32 v[24:25], v[24:25], s[44:45]
    v_pk_mul_f32 v[26:27], v[26:27], s[44:45]
    v_cvt_pk_bf16_f32 v40, v8, v9
    v_cvt_pk_bf16_f32 v41, v10, v11
    v_cvt_pk_bf16_f32 v42, v24, v25
    v_cvt_pk_bf16_f32 v43, v26, v27
    v_pk_mul_f32 v[12:13], v[12:13], s[44:45]
    v_pk_mul_f32 v[14:15], v[14:15], s[44:45]
    v_pk_mul_f32 v[28:29], v[28:29], s[44:45]
    v_pk_mul_f32 v[30:31], v[30:31], s[44:45]
    v_cvt_pk_bf16_f32 v44, v12, v13
    v_cvt_pk_bf16_f32 v45, v14, v15
    v_cvt_pk_bf16_f32 v46, v28, v29
    v_cvt_pk_bf16_f32 v47, v30, v31
    s_nop 1
    v_permlane16_swap_b32 v40, v44
    v_permlane16_swap_b32 v41, v45
    v_permlane16_swap_b32 v42, v46
    v_permlane16_swap_b32 v43, v47
    v_accvgpr_write_b32 a104, v40
    v_accvgpr_write_b32 a105, v41
    v_accvgpr_write_b32 a106, v42
    v_accvgpr_write_b32 a107, v43
    v_accvgpr_write_b32 a108, v44
    v_accvgpr_write_b32 a109, v45
    v_accvgpr_write_b32 a110, v46
    v_accvgpr_write_b32 a111, v47
    s_waitcnt lgkmcnt(0)
    v_and_b32 v136, 31, v143
    v_lshrrev_b32 v137, 5, v143
    v_lshlrev_b32 v137, 3, v137
    v_sub_u32 v138, v136, v137
    s_mul_i32 s36, s22, 49152
    s_lshl_b32 s37, s21, 13
    s_add_u32 s36, s36, s37
    v_add_u32 v137, s36, v142
    s_add_u32 s97, s94, 2
    s_mov_b32 s93, 0
    v_subrev_u32 v64, 0, v138
    v_ashrrev_i32 v64, 31, v64
    v_and_b32 v64, 0xff800000, v64
    v_subrev_u32 v65, 1, v138
    v_ashrrev_i32 v65, 31, v65
    v_and_b32 v65, 0xff800000, v65
    v_subrev_u32 v66, 2, v138
    v_ashrrev_i32 v66, 31, v66
    v_and_b32 v66, 0xff800000, v66
    v_subrev_u32 v67, 3, v138
    v_ashrrev_i32 v67, 31, v67
    v_and_b32 v67, 0xff800000, v67
    v_subrev_u32 v68, 16, v138
    v_ashrrev_i32 v68, 31, v68
    v_and_b32 v68, 0xff800000, v68
    v_subrev_u32 v69, 17, v138
    v_ashrrev_i32 v69, 31, v69
    v_and_b32 v69, 0xff800000, v69
    v_subrev_u32 v70, 18, v138
    v_ashrrev_i32 v70, 31, v70
    v_and_b32 v70, 0xff800000, v70
    v_subrev_u32 v71, 19, v138
    v_ashrrev_i32 v71, 31, v71
    v_and_b32 v71, 0xff800000, v71
    v_subrev_u32 v72, 4, v138
    v_ashrrev_i32 v72, 31, v72
    v_and_b32 v72, 0xff800000, v72
    v_subrev_u32 v73, 5, v138
    v_ashrrev_i32 v73, 31, v73
    v_and_b32 v73, 0xff800000, v73
    v_subrev_u32 v74, 6, v138
    v_ashrrev_i32 v74, 31, v74
    v_and_b32 v74, 0xff800000, v74
    v_subrev_u32 v75, 7, v138
    v_ashrrev_i32 v75, 31, v75
    v_and_b32 v75, 0xff800000, v75
    v_subrev_u32 v76, 20, v138
    v_ashrrev_i32 v76, 31, v76
    v_and_b32 v76, 0xff800000, v76
    v_subrev_u32 v77, 21, v138
    v_ashrrev_i32 v77, 31, v77
    v_and_b32 v77, 0xff800000, v77
    v_subrev_u32 v78, 22, v138
    v_ashrrev_i32 v78, 31, v78
    v_and_b32 v78, 0xff800000, v78
    v_subrev_u32 v79, 23, v138
    v_ashrrev_i32 v79, 31, v79
    v_and_b32 v79, 0xff800000, v79
    v_accvgpr_write_b32 a64, 0
    v_accvgpr_write_b32 a65, 0
    v_accvgpr_write_b32 a66, 0
    v_accvgpr_write_b32 a67, 0
    v_accvgpr_write_b32 a68, 0
    v_accvgpr_write_b32 a69, 0
    v_accvgpr_write_b32 a70, 0
    v_accvgpr_write_b32 a71, 0
    s_barrier
    v_mov_b32 v117, v137
    ds_read_b128 a[0:3], v117 offset:36864
    ds_read_b128 a[4:7], v117 offset:37888
    ds_read_b128 a[8:11], v117 offset:32768
    ds_read_b128 a[12:15], v117 offset:33792
    ds_read_b128 a[16:19], v117 offset:38912
    ds_read_b128 a[20:23], v117 offset:39936
    v_mov_b32 v119, v138
    v_bfe_u32 v124, v143, 2, 1
    v_subrev_u32 v124, 1, v124
    v_and_b32 v112, 0x3f803f80, v124
    v_mov_b32 v113, v112
    v_xor_b32 v114, 0x3f803f80, v112
    v_mov_b32 v115, v114
    v_and_b32 v124, 1, v143
    v_mul_u32_u24 v124, 0xaaaa, v124
    v_add_u32 v116, 0x4444, v124
    s_waitcnt lgkmcnt(2)
    v_mfma_f32_32x32x16_bf16 v[16:31], a[0:3], a[88:91], v[64:79]
    v_mfma_f32_32x32x16_bf16 v[16:31], a[4:7], a[92:95], v[16:31]
    v_mfma_f32_32x32x16_bf16 v[0:15], a[8:11], a[80:83], v[64:79]
    v_mfma_f32_32x32x16_bf16 v[0:15], a[12:15], a[84:87], v[0:15]
    ds_read_b128 a[0:3], v117 offset:28672
    ds_read_b128 a[4:7], v117 offset:29696
    ds_read_b128 a[24:27], v117 offset:34816
    ds_read_b128 a[28:31], v117 offset:35840
    s_nop 7
    v_max3_f32 v124, v16, v17, v18
    v_max3_f32 v125, v19, v20, v21
    v_max3_f32 v126, v22, v23, v24
    v_max3_f32 v127, v25, v26, v27
    v_max3_f32 v128, v28, v29, v30
    v_max3_f32 v124, v124, v125, v31
    v_max3_f32 v126, v126, v127, v128
    v_max_f32 v124, v124, v126
    v_mov_b32 v125, v124
    s_nop 1
    v_permlane32_swap_b32 v124, v125
    s_nop 1
    v_max_f32 v122, v124, v125
    v_sub_f32 v48, 0, v122
    v_sub_f32 v49, 0, v122
    v_sub_f32 v50, 0, v122
    v_sub_f32 v51, 0, v122
    v_sub_f32 v52, 0, v122
    v_sub_f32 v53, 0, v122
    v_sub_f32 v54, 0, v122
    v_sub_f32 v55, 0, v122
    v_sub_f32 v56, 0, v122
    v_sub_f32 v57, 0, v122
    v_sub_f32 v58, 0, v122
    v_sub_f32 v59, 0, v122
    v_sub_f32 v60, 0, v122
    v_sub_f32 v61, 0, v122
    v_sub_f32 v62, 0, v122
    v_sub_f32 v63, 0, v122
    v_sub_f32 v16, v16, v122
    v_sub_f32 v17, v17, v122
    v_sub_f32 v18, v18, v122
    v_sub_f32 v19, v19, v122
    v_sub_f32 v20, v20, v122
    v_sub_f32 v21, v21, v122
    v_sub_f32 v22, v22, v122
    v_sub_f32 v23, v23, v122
    v_sub_f32 v24, v24, v122
    v_sub_f32 v25, v25, v122
    v_sub_f32 v26, v26, v122
    v_sub_f32 v27, v27, v122
    v_sub_f32 v28, v28, v122
    v_sub_f32 v29, v29, v122
    v_sub_f32 v30, v30, v122
    v_sub_f32 v31, v31, v122
    v_exp_f32 v16, v16
    v_max3_f32 v124, v0, v1, v2
    v_max3_f32 v125, v3, v4, v5
    v_max3_f32 v126, v6, v7, v8
    v_max3_f32 v127, v9, v10, v11
    v_max3_f32 v128, v12, v13, v14
    v_max3_f32 v124, v124, v125, v15
    v_max3_f32 v126, v126, v127, v128
    v_max_f32 v124, v124, v126
    v_mov_b32 v125, v124
    s_nop 1
    v_permlane32_swap_b32 v124, v125
    s_nop 1
    v_max_f32 v121, v124, v125
    v_exp_f32 v17, v17
    v_exp_f32 v18, v18
    v_exp_f32 v19, v19
    v_cvt_pk_bf16_f32 v104, v16, v17
    v_sub_f32 v32, 0, v121
    v_sub_f32 v33, 0, v121
    v_sub_f32 v34, 0, v121
    v_sub_f32 v35, 0, v121
    v_sub_f32 v36, 0, v121
    v_sub_f32 v37, 0, v121
    v_sub_f32 v38, 0, v121
    v_sub_f32 v39, 0, v121
    v_sub_f32 v40, 0, v121
    v_sub_f32 v41, 0, v121
    v_sub_f32 v42, 0, v121
    v_sub_f32 v43, 0, v121
    v_sub_f32 v44, 0, v121
    v_sub_f32 v45, 0, v121
    v_sub_f32 v46, 0, v121
    v_sub_f32 v47, 0, v121
    v_cvt_pk_bf16_f32 v105, v18, v19
    v_exp_f32 v20, v20
    v_exp_f32 v21, v21
    v_exp_f32 v22, v22
    v_exp_f32 v23, v23
    v_sub_f32 v0, v0, v121
    v_sub_f32 v1, v1, v121
    v_sub_f32 v2, v2, v121
    v_sub_f32 v3, v3, v121
    v_sub_f32 v4, v4, v121
    v_sub_f32 v5, v5, v121
    v_sub_f32 v6, v6, v121
    v_sub_f32 v7, v7, v121
    v_sub_f32 v8, v8, v121
    v_sub_f32 v9, v9, v121
    v_sub_f32 v10, v10, v121
    v_sub_f32 v11, v11, v121
    v_sub_f32 v12, v12, v121
    v_sub_f32 v13, v13, v121
    v_sub_f32 v14, v14, v121
    v_sub_f32 v15, v15, v121
    v_cvt_pk_bf16_f32 v106, v20, v21
    v_cvt_pk_bf16_f32 v107, v22, v23
    v_exp_f32 v24, v24
    v_exp_f32 v25, v25
    v_exp_f32 v26, v26
    v_exp_f32 v27, v27
    v_cvt_pk_bf16_f32 v108, v24, v25
    v_cvt_pk_bf16_f32 v109, v26, v27
    v_exp_f32 v28, v28
    v_exp_f32 v29, v29
    v_exp_f32 v30, v30
    v_exp_f32 v31, v31
    v_cvt_pk_bf16_f32 v110, v28, v29
    v_cvt_pk_bf16_f32 v111, v30, v31
    s_waitcnt vmcnt(0)
    s_add_u32 s91, s91, 4096
    v_mov_b32 v139, s32
    v_min_u32 v140, 1, v143
    v_lshlrev_b32 v140, 30, v140
    buffer_store_dword v139, v140, s[12:15], s91 offen sc1
    s_waitcnt lgkmcnt(4)
    v_exp_f32 v0, v0
    v_mfma_f32_32x32x16_bf16 v[16:31], a[8:11], a[88:91], v[48:63]
    v_exp_f32 v1, v1
    v_exp_f32 v2, v2
    v_exp_f32 v3, v3
    v_cvt_pk_bf16_f32 v96, v0, v1
    v_mfma_f32_32x32x16_bf16 v[16:31], a[12:15], a[92:95], v[16:31]
    v_cvt_pk_bf16_f32 v97, v2, v3
    v_exp_f32 v4, v4
    v_exp_f32 v5, v5
    v_exp_f32 v6, v6
    v_exp_f32 v7, v7
    v_mfma_f32_32x32x16_bf16 a[48:63], a[16:19], v[104:107], 0
    v_cvt_pk_bf16_f32 v98, v4, v5
    v_cvt_pk_bf16_f32 v99, v6, v7
    v_exp_f32 v8, v8
    v_exp_f32 v9, v9
    v_exp_f32 v10, v10
    v_mfma_f32_32x32x16_bf16 a[48:63], a[20:23], v[108:111], a[48:63]
    v_exp_f32 v11, v11
    v_cvt_pk_bf16_f32 v100, v8, v9
    v_cvt_pk_bf16_f32 v101, v10, v11
    v_exp_f32 v12, v12
    v_exp_f32 v13, v13
    v_smfmac_f32_16x16x64_bf16 a[68:71], v[112:115], v[104:111], v116
    v_exp_f32 v14, v14
    v_exp_f32 v15, v15
    v_cvt_pk_bf16_f32 v102, v12, v13
    v_cvt_pk_bf16_f32 v103, v14, v15
    s_waitcnt lgkmcnt(0)
    v_exp_f32 v16, v16
    v_mfma_f32_32x32x16_bf16 v[0:15], a[0:3], a[80:83], v[32:47]
    ds_read_b128 a[8:11], v117 offset:24576
    v_exp_f32 v17, v17
    v_exp_f32 v18, v18
    v_exp_f32 v19, v19
    v_cvt_pk_bf16_f32 v104, v16, v17
    v_mfma_f32_32x32x16_bf16 v[0:15], a[4:7], a[84:87], v[0:15]
    ds_read_b128 a[12:15], v117 offset:25600
    v_cvt_pk_bf16_f32 v105, v18, v19
    v_exp_f32 v20, v20
    v_exp_f32 v21, v21
    v_exp_f32 v22, v22
    v_exp_f32 v23, v23
    v_mfma_f32_32x32x16_bf16 a[32:47], a[24:27], v[96:99], 0
    ds_read_b128 a[16:19], v117 offset:30720
    v_cvt_pk_bf16_f32 v106, v20, v21
    v_cvt_pk_bf16_f32 v107, v22, v23
    v_exp_f32 v24, v24
    v_exp_f32 v25, v25
    v_exp_f32 v26, v26
    v_mfma_f32_32x32x16_bf16 a[32:47], a[28:31], v[100:103], a[32:47]
    ds_read_b128 a[20:23], v117 offset:31744
    v_exp_f32 v27, v27
    v_cvt_pk_bf16_f32 v108, v24, v25
    v_cvt_pk_bf16_f32 v109, v26, v27
    v_exp_f32 v28, v28
    v_exp_f32 v29, v29
    v_smfmac_f32_16x16x64_bf16 a[64:67], v[112:115], v[96:103], v116
    v_exp_f32 v30, v30
    v_exp_f32 v31, v31
    v_cvt_pk_bf16_f32 v110, v28, v29
    v_cvt_pk_bf16_f32 v111, v30, v31
    s_cmp_le_u32 s97, 2
    s_cbranch_scc1 L_tail
    v_exp_f32 v0, v0
    v_mfma_f32_32x32x16_bf16 v[16:31], a[0:3], a[88:91], v[48:63]
    v_xor_b32 v64, 0xff800000, v64
    v_xor_b32 v65, 0xff800000, v65
    v_xor_b32 v66, 0xff800000, v66
    v_xor_b32 v67, 0xff800000, v67
    v_xor_b32 v68, 0xff800000, v68
    v_xor_b32 v69, 0xff800000, v69
    v_xor_b32 v70, 0xff800000, v70
    v_xor_b32 v71, 0xff800000, v71
    v_exp_f32 v1, v1
    v_exp_f32 v2, v2
    v_exp_f32 v3, v3
    v_cvt_pk_bf16_f32 v96, v0, v1
    v_mfma_f32_32x32x16_bf16 v[16:31], a[4:7], a[92:95], v[16:31]
    v_xor_b32 v72, 0xff800000, v72
    v_xor_b32 v73, 0xff800000, v73
    v_xor_b32 v74, 0xff800000, v74
    v_xor_b32 v75, 0xff800000, v75
    v_xor_b32 v76, 0xff800000, v76
    v_xor_b32 v77, 0xff800000, v77
    v_xor_b32 v78, 0xff800000, v78
    v_xor_b32 v79, 0xff800000, v79
    v_cvt_pk_bf16_f32 v97, v2, v3
    v_exp_f32 v4, v4
    v_exp_f32 v5, v5
    v_exp_f32 v6, v6
    v_exp_f32 v7, v7
    v_mfma_f32_32x32x16_bf16 a[48:63], a[24:27], v[104:107], a[48:63]
    v_add_f32 v80, v64, v48
    v_add_f32 v81, v65, v49
    v_add_f32 v82, v66, v50
    v_add_f32 v83, v67, v51
    v_add_f32 v84, v68, v52
    v_add_f32 v85, v69, v53
    v_add_f32 v86, v70, v54
    v_add_f32 v87, v71, v55
    v_cvt_pk_bf16_f32 v98, v4, v5
    v_cvt_pk_bf16_f32 v99, v6, v7
    v_exp_f32 v8, v8
    v_exp_f32 v9, v9
    v_exp_f32 v10, v10
    v_mfma_f32_32x32x16_bf16 a[48:63], a[28:31], v[108:111], a[48:63]
    v_add_f32 v88, v72, v56
    v_add_f32 v89, v73, v57
    v_add_f32 v90, v74, v58
    v_add_f32 v91, v75, v59
    v_add_f32 v92, v76, v60
    v_add_f32 v93, v77, v61
    v_add_f32 v94, v78, v62
    v_add_f32 v95, v79, v63
    v_exp_f32 v11, v11
    v_cvt_pk_bf16_f32 v100, v8, v9
    v_cvt_pk_bf16_f32 v101, v10, v11
    v_exp_f32 v12, v12
    v_exp_f32 v13, v13
    v_smfmac_f32_16x16x64_bf16 a[68:71], v[112:115], v[104:111], v116
    v_exp_f32 v14, v14
    v_exp_f32 v15, v15
    v_cvt_pk_bf16_f32 v102, v12, v13
    v_cvt_pk_bf16_f32 v103, v14, v15
    s_waitcnt lgkmcnt(0)
    v_exp_f32 v16, v16
    v_mfma_f32_32x32x16_bf16 v[0:15], a[8:11], a[80:83], v[32:47]
    ds_read_b128 a[0:3], v117 offset:20480
    v_add_f32 v64, v64, v32
    v_add_f32 v65, v65, v33
    v_add_f32 v66, v66, v34
    v_add_f32 v67, v67, v35
    v_exp_f32 v17, v17
    v_exp_f32 v18, v18
    v_exp_f32 v19, v19
    v_cvt_pk_bf16_f32 v104, v16, v17
    v_mfma_f32_32x32x16_bf16 v[0:15], a[12:15], a[84:87], v[0:15]
    ds_read_b128 a[4:7], v117 offset:21504
    v_add_f32 v68, v68, v36
    v_add_f32 v69, v69, v37
    v_add_f32 v70, v70, v38
    v_add_f32 v71, v71, v39
    v_cvt_pk_bf16_f32 v105, v18, v19
    v_exp_f32 v20, v20
    v_exp_f32 v21, v21
    v_exp_f32 v22, v22
    v_exp_f32 v23, v23
    v_mfma_f32_32x32x16_bf16 a[32:47], a[16:19], v[96:99], a[32:47]
    ds_read_b128 a[24:27], v117 offset:26624
    v_add_f32 v72, v72, v40
    v_add_f32 v73, v73, v41
    v_add_f32 v74, v74, v42
    v_add_f32 v75, v75, v43
    v_cvt_pk_bf16_f32 v106, v20, v21
    v_cvt_pk_bf16_f32 v107, v22, v23
    v_exp_f32 v24, v24
    v_exp_f32 v25, v25
    v_exp_f32 v26, v26
    v_mfma_f32_32x32x16_bf16 a[32:47], a[20:23], v[100:103], a[32:47]
    ds_read_b128 a[28:31], v117 offset:27648
    v_add_f32 v76, v76, v44
    v_add_f32 v77, v77, v45
    v_add_f32 v78, v78, v46
    v_add_f32 v79, v79, v47
    v_exp_f32 v27, v27
    v_cvt_pk_bf16_f32 v108, v24, v25
    v_cvt_pk_bf16_f32 v109, v26, v27
    v_exp_f32 v28, v28
    v_exp_f32 v29, v29
    v_smfmac_f32_16x16x64_bf16 a[64:67], v[112:115], v[96:103], v116
    v_exp_f32 v30, v30
    v_exp_f32 v31, v31
    v_cvt_pk_bf16_f32 v110, v28, v29
    v_cvt_pk_bf16_f32 v111, v30, v31
    v_exp_f32 v0, v0
    v_mfma_f32_32x32x16_bf16 v[16:31], a[8:11], a[88:91], v[48:63]
    v_exp_f32 v1, v1
    v_exp_f32 v2, v2
    v_exp_f32 v3, v3
    v_cvt_pk_bf16_f32 v96, v0, v1
    v_mfma_f32_32x32x16_bf16 v[16:31], a[12:15], a[92:95], v[16:31]
    v_cvt_pk_bf16_f32 v97, v2, v3
    v_exp_f32 v4, v4
    v_exp_f32 v5, v5
    v_exp_f32 v6, v6
    v_exp_f32 v7, v7
    v_mfma_f32_32x32x16_bf16 a[48:63], a[16:19], v[104:107], a[48:63]
    v_cvt_pk_bf16_f32 v98, v4, v5
    v_cvt_pk_bf16_f32 v99, v6, v7
    v_exp_f32 v8, v8
    v_exp_f32 v9, v9
    v_exp_f32 v10, v10
    v_mfma_f32_32x32x16_bf16 a[48:63], a[20:23], v[108:111], a[48:63]
    v_exp_f32 v11, v11
    v_cvt_pk_bf16_f32 v100, v8, v9
    v_cvt_pk_bf16_f32 v101, v10, v11
    v_exp_f32 v12, v12
    v_exp_f32 v13, v13
    v_smfmac_f32_16x16x64_bf16 a[68:71], v[112:115], v[104:111], v116
    v_exp_f32 v14, v14
    v_exp_f32 v15, v15
    v_cvt_pk_bf16_f32 v102, v12, v13
    v_cvt_pk_bf16_f32 v103, v14, v15
    s_waitcnt lgkmcnt(0)
    v_exp_f32 v16, v16
    v_mfma_f32_32x32x16_bf16 v[0:15], a[0:3], a[80:83], v[32:47]
    ds_read_b128 a[8:11], v117 offset:16384
    v_exp_f32 v17, v17
    v_exp_f32 v18, v18
    v_exp_f32 v19, v19
    v_cvt_pk_bf16_f32 v104, v16, v17
    v_mfma_f32_32x32x16_bf16 v[0:15], a[4:7], a[84:87], v[0:15]
    ds_read_b128 a[12:15], v117 offset:17408
    v_cvt_pk_bf16_f32 v105, v18, v19
    v_exp_f32 v20, v20
    v_exp_f32 v21, v21
    v_exp_f32 v22, v22
    v_exp_f32 v23, v23
    v_mfma_f32_32x32x16_bf16 a[32:47], a[24:27], v[96:99], a[32:47]
    ds_read_b128 a[16:19], v117 offset:22528
    v_cvt_pk_bf16_f32 v106, v20, v21
    v_cvt_pk_bf16_f32 v107, v22, v23
    v_exp_f32 v24, v24
    v_exp_f32 v25, v25
    v_exp_f32 v26, v26
    v_mfma_f32_32x32x16_bf16 a[32:47], a[28:31], v[100:103], a[32:47]
    ds_read_b128 a[20:23], v117 offset:23552
    v_exp_f32 v27, v27
    v_cvt_pk_bf16_f32 v108, v24, v25
    v_cvt_pk_bf16_f32 v109, v26, v27
    v_exp_f32 v28, v28
    v_exp_f32 v29, v29
    v_smfmac_f32_16x16x64_bf16 a[64:67], v[112:115], v[96:103], v116
    v_exp_f32 v30, v30
    v_exp_f32 v31, v31
    v_cvt_pk_bf16_f32 v110, v28, v29
    v_cvt_pk_bf16_f32 v111, v30, v31
    s_cmp_le_u32 s97, 4
    s_cbranch_scc1 L_tail
    v_exp_f32 v0, v0
    v_mfma_f32_32x32x16_bf16 v[16:31], a[0:3], a[88:91], v[48:63]
    v_exp_f32 v1, v1
    v_exp_f32 v2, v2
    v_exp_f32 v3, v3
    v_cvt_pk_bf16_f32 v96, v0, v1
    v_mfma_f32_32x32x16_bf16 v[16:31], a[4:7], a[92:95], v[16:31]
    v_cvt_pk_bf16_f32 v97, v2, v3
    v_exp_f32 v4, v4
    v_exp_f32 v5, v5
    v_exp_f32 v6, v6
    v_exp_f32 v7, v7
    v_mfma_f32_32x32x16_bf16 a[48:63], a[24:27], v[104:107], a[48:63]
    v_cvt_pk_bf16_f32 v98, v4, v5
    v_cvt_pk_bf16_f32 v99, v6, v7
    v_exp_f32 v8, v8
    v_exp_f32 v9, v9
    v_exp_f32 v10, v10
    v_mfma_f32_32x32x16_bf16 a[48:63], a[28:31], v[108:111], a[48:63]
    v_exp_f32 v11, v11
    v_cvt_pk_bf16_f32 v100, v8, v9
    v_cvt_pk_bf16_f32 v101, v10, v11
    v_exp_f32 v12, v12
    v_exp_f32 v13, v13
    v_smfmac_f32_16x16x64_bf16 a[68:71], v[112:115], v[104:111], v116
    v_exp_f32 v14, v14
    v_exp_f32 v15, v15
    v_cvt_pk_bf16_f32 v102, v12, v13
    v_cvt_pk_bf16_f32 v103, v14, v15
    s_waitcnt lgkmcnt(0)
    v_exp_f32 v16, v16
    v_mfma_f32_32x32x16_bf16 v[0:15], a[8:11], a[80:83], v[32:47]
    ds_read_b128 a[0:3], v117 offset:12288
    v_exp_f32 v17, v17
    v_exp_f32 v18, v18
    v_exp_f32 v19, v19
    v_cvt_pk_bf16_f32 v104, v16, v17
    v_mfma_f32_32x32x16_bf16 v[0:15], a[12:15], a[84:87], v[0:15]
    ds_read_b128 a[4:7], v117 offset:13312
    v_cvt_pk_bf16_f32 v105, v18, v19
    v_exp_f32 v20, v20
    v_exp_f32 v21, v21
    v_exp_f32 v22, v22
    v_exp_f32 v23, v23
    v_mfma_f32_32x32x16_bf16 a[32:47], a[16:19], v[96:99], a[32:47]
    ds_read_b128 a[24:27], v117 offset:18432
    v_cvt_pk_bf16_f32 v106, v20, v21
    v_cvt_pk_bf16_f32 v107, v22, v23
    v_exp_f32 v24, v24
    v_exp_f32 v25, v25
    v_exp_f32 v26, v26
    v_mfma_f32_32x32x16_bf16 a[32:47], a[20:23], v[100:103], a[32:47]
    ds_read_b128 a[28:31], v117 offset:19456
    v_exp_f32 v27, v27
    v_cvt_pk_bf16_f32 v108, v24, v25
    v_cvt_pk_bf16_f32 v109, v26, v27
    v_exp_f32 v28, v28
    v_exp_f32 v29, v29
    v_smfmac_f32_16x16x64_bf16 a[64:67], v[112:115], v[96:103], v116
    v_exp_f32 v30, v30
    v_exp_f32 v31, v31
    v_cvt_pk_bf16_f32 v110, v28, v29
    v_cvt_pk_bf16_f32 v111, v30, v31
    v_exp_f32 v0, v0
    v_mfma_f32_32x32x16_bf16 v[16:31], a[8:11], a[88:91], v[48:63]
    v_exp_f32 v1, v1
    v_exp_f32 v2, v2
    v_exp_f32 v3, v3
    v_cvt_pk_bf16_f32 v96, v0, v1
    v_mfma_f32_32x32x16_bf16 v[16:31], a[12:15], a[92:95], v[16:31]
    v_cvt_pk_bf16_f32 v97, v2, v3
    v_exp_f32 v4, v4
    v_exp_f32 v5, v5
    v_exp_f32 v6, v6
    v_exp_f32 v7, v7
    v_mfma_f32_32x32x16_bf16 a[48:63], a[16:19], v[104:107], a[48:63]
    v_cvt_pk_bf16_f32 v98, v4, v5
    v_cvt_pk_bf16_f32 v99, v6, v7
    v_exp_f32 v8, v8
    v_exp_f32 v9, v9
    v_exp_f32 v10, v10
    v_mfma_f32_32x32x16_bf16 a[48:63], a[20:23], v[108:111], a[48:63]
    v_exp_f32 v11, v11
    v_cvt_pk_bf16_f32 v100, v8, v9
    v_cvt_pk_bf16_f32 v101, v10, v11
    v_exp_f32 v12, v12
    v_exp_f32 v13, v13
    v_smfmac_f32_16x16x64_bf16 a[68:71], v[112:115], v[104:111], v116
    v_exp_f32 v14, v14
    v_exp_f32 v15, v15
    v_cvt_pk_bf16_f32 v102, v12, v13
    v_cvt_pk_bf16_f32 v103, v14, v15
    s_waitcnt lgkmcnt(0)
    v_exp_f32 v16, v16
    v_mfma_f32_32x32x16_bf16 v[0:15], a[0:3], a[80:83], v[32:47]
    ds_read_b128 a[8:11], v117 offset:8192
    v_exp_f32 v17, v17
    v_exp_f32 v18, v18
    v_exp_f32 v19, v19
    v_cvt_pk_bf16_f32 v104, v16, v17
    v_mfma_f32_32x32x16_bf16 v[0:15], a[4:7], a[84:87], v[0:15]
    ds_read_b128 a[12:15], v117 offset:9216
    v_cvt_pk_bf16_f32 v105, v18, v19
    v_exp_f32 v20, v20
    v_exp_f32 v21, v21
    v_exp_f32 v22, v22
    v_exp_f32 v23, v23
    v_mfma_f32_32x32x16_bf16 a[32:47], a[24:27], v[96:99], a[32:47]
    ds_read_b128 a[16:19], v117 offset:14336
    v_cvt_pk_bf16_f32 v106, v20, v21
    v_cvt_pk_bf16_f32 v107, v22, v23
    v_exp_f32 v24, v24
    v_exp_f32 v25, v25
    v_exp_f32 v26, v26
    v_mfma_f32_32x32x16_bf16 a[32:47], a[28:31], v[100:103], a[32:47]
    ds_read_b128 a[20:23], v117 offset:15360
    v_exp_f32 v27, v27
    v_cvt_pk_bf16_f32 v108, v24, v25
    v_cvt_pk_bf16_f32 v109, v26, v27
    v_exp_f32 v28, v28
    v_exp_f32 v29, v29
    v_smfmac_f32_16x16x64_bf16 a[64:67], v[112:115], v[96:103], v116
    v_exp_f32 v30, v30
    v_exp_f32 v31, v31
    v_cvt_pk_bf16_f32 v110, v28, v29
    v_cvt_pk_bf16_f32 v111, v30, v31
    s_cmp_le_u32 s97, 6
    s_cbranch_scc1 L_tail
    v_exp_f32 v0, v0
    v_mfma_f32_32x32x16_bf16 v[16:31], a[0:3], a[88:91], v[48:63]
    v_exp_f32 v1, v1
    v_exp_f32 v2, v2
    v_exp_f32 v3, v3
    v_cvt_pk_bf16_f32 v96, v0, v1
    v_mfma_f32_32x32x16_bf16 v[16:31], a[4:7], a[92:95], v[16:31]
    v_cvt_pk_bf16_f32 v97, v2, v3
    v_exp_f32 v4, v4
    v_exp_f32 v5, v5
    v_exp_f32 v6, v6
    v_exp_f32 v7, v7
    v_mfma_f32_32x32x16_bf16 a[48:63], a[24:27], v[104:107], a[48:63]
    v_cvt_pk_bf16_f32 v98, v4, v5
    v_cvt_pk_bf16_f32 v99, v6, v7
    v_exp_f32 v8, v8
    v_exp_f32 v9, v9
    v_exp_f32 v10, v10
    v_mfma_f32_32x32x16_bf16 a[48:63], a[28:31], v[108:111], a[48:63]
    v_exp_f32 v11, v11
    v_cvt_pk_bf16_f32 v100, v8, v9
    v_cvt_pk_bf16_f32 v101, v10, v11
    v_exp_f32 v12, v12
    v_exp_f32 v13, v13
    v_smfmac_f32_16x16x64_bf16 a[68:71], v[112:115], v[104:111], v116
    v_exp_f32 v14, v14
    v_exp_f32 v15, v15
    v_cvt_pk_bf16_f32 v102, v12, v13
    v_cvt_pk_bf16_f32 v103, v14, v15
    s_waitcnt lgkmcnt(0)
    v_exp_f32 v16, v16
    v_mfma_f32_32x32x16_bf16 v[0:15], a[8:11], a[80:83], v[32:47]
    ds_read_b128 a[0:3], v117 offset:4096
    v_exp_f32 v17, v17
    v_exp_f32 v18, v18
    v_exp_f32 v19, v19
    v_cvt_pk_bf16_f32 v104, v16, v17
    v_mfma_f32_32x32x16_bf16 v[0:15], a[12:15], a[84:87], v[0:15]
    ds_read_b128 a[4:7], v117 offset:5120
    v_cvt_pk_bf16_f32 v105, v18, v19
    v_exp_f32 v20, v20
    v_exp_f32 v21, v21
    v_exp_f32 v22, v22
    v_exp_f32 v23, v23
    v_mfma_f32_32x32x16_bf16 a[32:47], a[16:19], v[96:99], a[32:47]
    ds_read_b128 a[24:27], v117 offset:10240
    v_cvt_pk_bf16_f32 v106, v20, v21
    v_cvt_pk_bf16_f32 v107, v22, v23
    v_exp_f32 v24, v24
    v_exp_f32 v25, v25
    v_exp_f32 v26, v26
    v_mfma_f32_32x32x16_bf16 a[32:47], a[20:23], v[100:103], a[32:47]
    ds_read_b128 a[28:31], v117 offset:11264
    v_exp_f32 v27, v27
    v_cvt_pk_bf16_f32 v108, v24, v25
    v_cvt_pk_bf16_f32 v109, v26, v27
    v_exp_f32 v28, v28
    v_exp_f32 v29, v29
    v_smfmac_f32_16x16x64_bf16 a[64:67], v[112:115], v[96:103], v116
    v_exp_f32 v30, v30
    v_exp_f32 v31, v31
    v_cvt_pk_bf16_f32 v110, v28, v29
    v_cvt_pk_bf16_f32 v111, v30, v31
    v_exp_f32 v0, v0
    v_mfma_f32_32x32x16_bf16 v[16:31], a[8:11], a[88:91], v[48:63]
    v_exp_f32 v1, v1
    v_exp_f32 v2, v2
    v_exp_f32 v3, v3
    v_cvt_pk_bf16_f32 v96, v0, v1
    v_mfma_f32_32x32x16_bf16 v[16:31], a[12:15], a[92:95], v[16:31]
    v_cvt_pk_bf16_f32 v97, v2, v3
    v_exp_f32 v4, v4
    v_exp_f32 v5, v5
    v_exp_f32 v6, v6
    v_exp_f32 v7, v7
    v_mfma_f32_32x32x16_bf16 a[48:63], a[16:19], v[104:107], a[48:63]
    v_cvt_pk_bf16_f32 v98, v4, v5
    v_cvt_pk_bf16_f32 v99, v6, v7
    v_exp_f32 v8, v8
    v_exp_f32 v9, v9
    v_exp_f32 v10, v10
    v_mfma_f32_32x32x16_bf16 a[48:63], a[20:23], v[108:111], a[48:63]
    v_exp_f32 v11, v11
    v_cvt_pk_bf16_f32 v100, v8, v9
    v_cvt_pk_bf16_f32 v101, v10, v11
    v_exp_f32 v12, v12
    v_exp_f32 v13, v13
    v_smfmac_f32_16x16x64_bf16 a[68:71], v[112:115], v[104:111], v116
    v_exp_f32 v14, v14
    v_exp_f32 v15, v15
    v_cvt_pk_bf16_f32 v102, v12, v13
    v_cvt_pk_bf16_f32 v103, v14, v15
    s_waitcnt lgkmcnt(0)
    v_exp_f32 v16, v16
    v_mfma_f32_32x32x16_bf16 v[0:15], a[0:3], a[80:83], v[32:47]
    ds_read_b128 a[8:11], v117 offset:0
    v_exp_f32 v17, v17
    v_exp_f32 v18, v18
    v_exp_f32 v19, v19
    v_cvt_pk_bf16_f32 v104, v16, v17
    v_mfma_f32_32x32x16_bf16 v[0:15], a[4:7], a[84:87], v[0:15]
    ds_read_b128 a[12:15], v117 offset:1024
    v_cvt_pk_bf16_f32 v105, v18, v19
    v_exp_f32 v20, v20
    v_exp_f32 v21, v21
    v_exp_f32 v22, v22
    v_exp_f32 v23, v23
    v_mfma_f32_32x32x16_bf16 a[32:47], a[24:27], v[96:99], a[32:47]
    ds_read_b128 a[16:19], v117 offset:6144
    v_cvt_pk_bf16_f32 v106, v20, v21
    v_cvt_pk_bf16_f32 v107, v22, v23
    v_exp_f32 v24, v24
    v_exp_f32 v25, v25
    v_exp_f32 v26, v26
    v_mfma_f32_32x32x16_bf16 a[32:47], a[28:31], v[100:103], a[32:47]
    ds_read_b128 a[20:23], v117 offset:7168
    v_exp_f32 v27, v27
    v_cvt_pk_bf16_f32 v108, v24, v25
    v_cvt_pk_bf16_f32 v109, v26, v27
    v_exp_f32 v28, v28
    v_exp_f32 v29, v29
    v_smfmac_f32_16x16x64_bf16 a[64:67], v[112:115], v[96:103], v116
    v_exp_f32 v30, v30
    v_exp_f32 v31, v31
    v_cvt_pk_bf16_f32 v110, v28, v29
    v_cvt_pk_bf16_f32 v111, v30, v31
    s_cmp_le_u32 s97, 8
    s_cbranch_scc1 L_tail
    v_exp_f32 v0, v0
    v_mfma_f32_32x32x16_bf16 v[16:31], a[0:3], a[88:91], v[80:95]
    v_exp_f32 v1, v1
    v_exp_f32 v2, v2
    v_exp_f32 v3, v3
    v_cvt_pk_bf16_f32 v96, v0, v1
    v_mfma_f32_32x32x16_bf16 v[16:31], a[4:7], a[92:95], v[16:31]
    v_cvt_pk_bf16_f32 v97, v2, v3
    v_exp_f32 v4, v4
    v_exp_f32 v5, v5
    v_exp_f32 v6, v6
    v_exp_f32 v7, v7
    v_mfma_f32_32x32x16_bf16 a[48:63], a[24:27], v[104:107], a[48:63]
    v_cvt_pk_bf16_f32 v98, v4, v5
    v_cvt_pk_bf16_f32 v99, v6, v7
    v_exp_f32 v8, v8
    v_exp_f32 v9, v9
    v_exp_f32 v10, v10
    v_mfma_f32_32x32x16_bf16 a[48:63], a[28:31], v[108:111], a[48:63]
    v_exp_f32 v11, v11
    v_cvt_pk_bf16_f32 v100, v8, v9
    v_cvt_pk_bf16_f32 v101, v10, v11
    v_exp_f32 v12, v12
    v_exp_f32 v13, v13
    v_smfmac_f32_16x16x64_bf16 a[68:71], v[112:115], v[104:111], v116
    v_exp_f32 v14, v14
    v_exp_f32 v15, v15
    v_cvt_pk_bf16_f32 v102, v12, v13
    v_cvt_pk_bf16_f32 v103, v14, v15
    s_waitcnt lgkmcnt(0)
    v_exp_f32 v16, v16
    v_mfma_f32_32x32x16_bf16 v[0:15], a[8:11], a[80:83], v[64:79]
    v_exp_f32 v17, v17
    v_exp_f32 v18, v18
    v_exp_f32 v19, v19
    v_cvt_pk_bf16_f32 v104, v16, v17
    v_mfma_f32_32x32x16_bf16 v[0:15], a[12:15], a[84:87], v[0:15]
    v_cvt_pk_bf16_f32 v105, v18, v19
    v_exp_f32 v20, v20
    v_exp_f32 v21, v21
    v_exp_f32 v22, v22
    v_exp_f32 v23, v23
    v_mfma_f32_32x32x16_bf16 a[32:47], a[16:19], v[96:99], a[32:47]
    ds_read_b128 a[24:27], v117 offset:2048
    v_cvt_pk_bf16_f32 v106, v20, v21
    v_cvt_pk_bf16_f32 v107, v22, v23
    v_exp_f32 v24, v24
    v_exp_f32 v25, v25
    v_exp_f32 v26, v26
    v_mfma_f32_32x32x16_bf16 a[32:47], a[20:23], v[100:103], a[32:47]
    ds_read_b128 a[28:31], v117 offset:3072
    v_exp_f32 v27, v27
    v_cvt_pk_bf16_f32 v108, v24, v25
    v_cvt_pk_bf16_f32 v109, v26, v27
    v_exp_f32 v28, v28
    v_exp_f32 v29, v29
    v_smfmac_f32_16x16x64_bf16 a[64:67], v[112:115], v[96:103], v116
    v_exp_f32 v30, v30
    v_exp_f32 v31, v31
    v_cvt_pk_bf16_f32 v110, v28, v29
    v_cvt_pk_bf16_f32 v111, v30, v31
    v_exp_f32 v0, v0
    v_exp_f32 v1, v1
    v_exp_f32 v2, v2
    v_exp_f32 v3, v3
    v_cvt_pk_bf16_f32 v96, v0, v1
    v_cvt_pk_bf16_f32 v97, v2, v3
    v_exp_f32 v4, v4
    v_exp_f32 v5, v5
    v_exp_f32 v6, v6
    v_exp_f32 v7, v7
    v_mfma_f32_32x32x16_bf16 a[48:63], a[16:19], v[104:107], a[48:63]
    v_cvt_pk_bf16_f32 v98, v4, v5
    v_cvt_pk_bf16_f32 v99, v6, v7
    v_exp_f32 v8, v8
    v_exp_f32 v9, v9
    v_exp_f32 v10, v10
    v_mfma_f32_32x32x16_bf16 a[48:63], a[20:23], v[108:111], a[48:63]
    v_exp_f32 v11, v11
    v_cvt_pk_bf16_f32 v100, v8, v9
    v_cvt_pk_bf16_f32 v101, v10, v11
    v_exp_f32 v12, v12
    v_exp_f32 v13, v13
    v_smfmac_f32_16x16x64_bf16 a[68:71], v[112:115], v[104:111], v116
    v_exp_f32 v14, v14
    v_exp_f32 v15, v15
    v_cvt_pk_bf16_f32 v102, v12, v13
    v_cvt_pk_bf16_f32 v103, v14, v15
    s_nop 0
    s_waitcnt lgkmcnt(0)
    v_mfma_f32_32x32x16_bf16 a[32:47], a[24:27], v[96:99], a[32:47]
    v_mfma_f32_32x32x16_bf16 a[32:47], a[28:31], v[100:103], a[32:47]
    v_smfmac_f32_16x16x64_bf16 a[64:67], v[112:115], v[96:103], v116
    s_nop 7
    s_branch L_tail2
L_tail:
    s_nop 0
    s_waitcnt lgkmcnt(0)
    v_mfma_f32_32x32x16_bf16 a[48:63], a[24:27], v[104:107], a[48:63]
    v_mfma_f32_32x32x16_bf16 a[48:63], a[28:31], v[108:111], a[48:63]
    v_smfmac_f32_16x16x64_bf16 a[68:71], v[112:115], v[104:111], v116
L_tail2:
    s_barrier
    s_lshl_b32 s36, s94, 6
    s_add_u32 s36, s36, s95
    s_lshl_b32 s37, s93, 5
    s_add_u32 s36, s36, s37
    s_lshl_b32 s36, s36, 11
    s_add_u32 s96, s36, 20971520
    s_mov_b32 s40, 0x3f803f80
    s_nop 4
    v_accvgpr_read_b32 v124, a64
    v_accvgpr_read_b32 v125, a65
    v_accvgpr_read_b32 v32, a32
    v_accvgpr_read_b32 v33, a33
    v_accvgpr_read_b32 v34, a34
    v_accvgpr_read_b32 v35, a35
    v_accvgpr_read_b32 v36, a36
    v_accvgpr_read_b32 v37, a37
    v_accvgpr_read_b32 v38, a38
    v_accvgpr_read_b32 v39, a39
    v_accvgpr_read_b32 v40, a40
    v_accvgpr_read_b32 v41, a41
    v_accvgpr_read_b32 v42, a42
    v_accvgpr_read_b32 v43, a43
    v_accvgpr_read_b32 v44, a44
    v_accvgpr_read_b32 v45, a45
    v_accvgpr_read_b32 v46, a46
    v_accvgpr_read_b32 v47, a47
    v_add_f32 v124, v124, v125
    s_mov_b32 s41, 0
L_st_a:
    v_rcp_f32 v126, v124
    v_mov_b32 v128, 0x5d800000
    v_mov_b32 v127, v126
    v_cmp_nlt_f32 s[42:43], v124, v128
    v_pk_mul_f32 v[32:33], v[32:33], v[126:127]
    v_pk_mul_f32 v[34:35], v[34:35], v[126:127]
    v_pk_mul_f32 v[36:37], v[36:37], v[126:127]
    v_pk_mul_f32 v[38:39], v[38:39], v[126:127]
    v_pk_mul_f32 v[40:41], v[40:41], v[126:127]
    v_pk_mul_f32 v[42:43], v[42:43], v[126:127]
    v_pk_mul_f32 v[44:45], v[44:45], v[126:127]
    v_pk_mul_f32 v[46:47], v[46:47], v[126:127]
    v_cvt_pk_bf16_f32 v0, v32, v33
    v_cvt_pk_bf16_f32 v1, v34, v35
    v_cvt_pk_bf16_f32 v2, v36, v37
    v_cvt_pk_bf16_f32 v3, v38, v39
    v_cvt_pk_bf16_f32 v4, v40, v41
    v_cvt_pk_bf16_f32 v5, v42, v43
    v_cvt_pk_bf16_f32 v6, v44, v45
    v_cvt_pk_bf16_f32 v7, v46, v47
    v_mov_b32 v129, 0
    v_mov_b32 v130, 0x7f800000
    v_dot2_f32_bf16 v129, v0, s40, v129
    v_dot2_f32_bf16 v129, v1, s40, v129
    v_dot2_f32_bf16 v129, v2, s40, v129
    v_dot2_f32_bf16 v129, v3, s40, v129
    v_dot2_f32_bf16 v129, v4, s40, v129
    v_dot2_f32_bf16 v129, v5, s40, v129
    v_dot2_f32_bf16 v129, v6, s40, v129
    v_dot2_f32_bf16 v129, v7, s40, v129
    s_nop 2
    v_cmp_nlt_f32 vcc, |v129|, v130
    s_nop 3
    s_or_b64 vcc, vcc, s[42:43]
    s_cbranch_vccz L_ok_a
    s_cmp_eq_u32 s41, 0
    s_cbranch_scc1 L_fb_a
L_ok_a:
    buffer_store_dwordx4 v[0:3], v142, s[12:15], s96 offen sc1
    buffer_store_dwordx4 v[4:7], v142, s[12:15], s96 offen offset:1024 sc1
    s_add_u32 s96, s96, 0x20000
    v_accvgpr_read_b32 v124, a68
    v_accvgpr_read_b32 v125, a69
    v_accvgpr_read_b32 v48, a48
    v_accvgpr_read_b32 v49, a49
    v_accvgpr_read_b32 v50, a50
    v_accvgpr_read_b32 v51, a51
    v_accvgpr_read_b32 v52, a52
    v_accvgpr_read_b32 v53, a53
    v_accvgpr_read_b32 v54, a54
    v_accvgpr_read_b32 v55, a55
    v_accvgpr_read_b32 v56, a56
    v_accvgpr_read_b32 v57, a57
    v_accvgpr_read_b32 v58, a58
    v_accvgpr_read_b32 v59, a59
    v_accvgpr_read_b32 v60, a60
    v_accvgpr_read_b32 v61, a61
    v_accvgpr_read_b32 v62, a62
    v_accvgpr_read_b32 v63, a63
    v_add_f32 v124, v124, v125
    s_mov_b32 s41, 0
L_st_b:
    v_rcp_f32 v126, v124
    v_mov_b32 v128, 0x5d800000
    v_mov_b32 v127, v126
    v_cmp_nlt_f32 s[42:43], v124, v128
    v_pk_mul_f32 v[48:49], v[48:49], v[126:127]
    v_pk_mul_f32 v[50:51], v[50:51], v[126:127]
    v_pk_mul_f32 v[52:53], v[52:53], v[126:127]
    v_pk_mul_f32 v[54:55], v[54:55], v[126:127]
    v_pk_mul_f32 v[56:57], v[56:57], v[126:127]
    v_pk_mul_f32 v[58:59], v[58:59], v[126:127]
    v_pk_mul_f32 v[60:61], v[60:61], v[126:127]
    v_pk_mul_f32 v[62:63], v[62:63], v[126:127]
    v_cvt_pk_bf16_f32 v16, v48, v49
    v_cvt_pk_bf16_f32 v17, v50, v51
    v_cvt_pk_bf16_f32 v18, v52, v53
    v_cvt_pk_bf16_f32 v19, v54, v55
    v_cvt_pk_bf16_f32 v20, v56, v57
    v_cvt_pk_bf16_f32 v21, v58, v59
    v_cvt_pk_bf16_f32 v22, v60, v61
    v_cvt_pk_bf16_f32 v23, v62, v63
    v_mov_b32 v129, 0
    v_mov_b32 v130, 0x7f800000
    v_dot2_f32_bf16 v129, v16, s40, v129
    v_dot2_f32_bf16 v129, v17, s40, v129
    v_dot2_f32_bf16 v129, v18, s40, v129
    v_dot2_f32_bf16 v129, v19, s40, v129
    v_dot2_f32_bf16 v129, v20, s40, v129
    v_dot2_f32_bf16 v129, v21, s40, v129
    v_dot2_f32_bf16 v129, v22, s40, v129
    v_dot2_f32_bf16 v129, v23, s40, v129
    s_nop 2
    v_cmp_nlt_f32 vcc, |v129|, v130
    s_nop 3
    s_or_b64 vcc, vcc, s[42:43]
    s_cbranch_vccz L_ok_b
    s_cmp_eq_u32 s41, 0
    s_cbranch_scc1 L_fb_b
L_ok_b:
    buffer_store_dwordx4 v[16:19], v142, s[12:15], s96 offen sc1
    buffer_store_dwordx4 v[20:23], v142, s[12:15], s96 offen offset:1024 sc1
    s_add_u32 s96, s96, 0x20000
    s_cmp_lg_u32 s93, 0
    s_cbranch_scc1 L_oproj
    s_mov_b32 s93, 1
    s_lshl_b32 s36, s22, 14
    v_add_u32 v120, s36, v142
    v_add_u32 v117, 98304, v120
    v_add_u32 v118, 131072, v120
    s_mov_b32 s30, 131072
    s_mov_b32 s31, 163840
    s_mov_b32 s25, 0
    s_mov_b32 s33, 1
    ds_read_b128 a[0:3], v117 offset:0
    ds_read_b128 a[4:7], v117 offset:1024
    v_accvgpr_write_b32 a32, 0
    v_accvgpr_write_b32 a33, 0
    v_accvgpr_write_b32 a34, 0
    v_accvgpr_write_b32 a35, 0
    v_accvgpr_write_b32 a36, 0
    v_accvgpr_write_b32 a37, 0
    v_accvgpr_write_b32 a38, 0
    v_accvgpr_write_b32 a39, 0
    v_accvgpr_write_b32 a40, 0
    v_accvgpr_write_b32 a41, 0
    v_accvgpr_write_b32 a42, 0
    v_accvgpr_write_b32 a43, 0
    v_accvgpr_write_b32 a44, 0
    v_accvgpr_write_b32 a45, 0
    v_accvgpr_write_b32 a46, 0
    v_accvgpr_write_b32 a47, 0
    v_accvgpr_write_b32 a64, 0
    v_accvgpr_write_b32 a65, 0
    v_accvgpr_write_b32 a66, 0
    v_accvgpr_write_b32 a67, 0
    v_accvgpr_write_b32 a48, 0
    v_accvgpr_write_b32 a49, 0
    v_accvgpr_write_b32 a50, 0
    v_accvgpr_write_b32 a51, 0
    s_waitcnt lgkmcnt(0)
    v_mfma_f32_32x32x16_bf16 v[0:15], a[0:3], a[96:99], 0
    v_mfma_f32_32x32x16_bf16 v[0:15], a[4:7], a[100:103], v[0:15]
    v_mfma_f32_32x32x16_bf16 v[16:31], a[0:3], a[104:107], 0
    v_mfma_f32_32x32x16_bf16 v[16:31], a[4:7], a[108:111], v[16:31]
    ds_read_b128 a[8:11], v117 offset:4096
    ds_read_b128 a[12:15], v117 offset:5120
    ds_read_b128 a[16:19], v117 offset:2048
    ds_read_b128 a[20:23], v117 offset:3072
    v_accvgpr_write_b32 a52, 0
    v_accvgpr_write_b32 a53, 0
    v_accvgpr_write_b32 a54, 0
    v_accvgpr_write_b32 a55, 0
    v_accvgpr_write_b32 a56, 0
    v_accvgpr_write_b32 a57, 0
    v_accvgpr_write_b32 a58, 0
    v_accvgpr_write_b32 a59, 0
    v_accvgpr_write_b32 a60, 0
    v_accvgpr_write_b32 a61, 0
    v_accvgpr_write_b32 a62, 0
    v_accvgpr_write_b32 a63, 0
    v_accvgpr_write_b32 a68, 0
    v_accvgpr_write_b32 a69, 0
    v_accvgpr_write_b32 a70, 0
    v_accvgpr_write_b32 a71, 0
    v_mov_b32 v104, 0
    v_accvgpr_write_b32 a24, 0
    v_mov_b32 v105, 0
    v_accvgpr_write_b32 a25, 0
    v_mov_b32 v106, 0
    v_accvgpr_write_b32 a26, 0
    v_mov_b32 v107, 0
    v_accvgpr_write_b32 a27, 0
    v_mov_b32 v108, 0
    v_accvgpr_write_b32 a28, 0
    v_mov_b32 v109, 0
    v_accvgpr_write_b32 a29, 0
    v_mov_b32 v110, 0
    v_accvgpr_write_b32 a30, 0
    v_mov_b32 v111, 0
    v_accvgpr_write_b32 a31, 0
    v_max3_f32 v124, v0, v1, v2
    v_max3_f32 v125, v3, v4, v5
    v_max3_f32 v126, v6, v7, v8
    v_max3_f32 v127, v9, v10, v11
    v_max3_f32 v128, v12, v13, v14
    v_max3_f32 v124, v124, v125, v15
    v_max3_f32 v126, v126, v127, v128
    v_max_f32 v124, v124, v126
    v_mov_b32 v125, v124
    s_nop 1
    v_permlane32_swap_b32 v124, v125
    s_nop 1
    v_max_f32 v121, v124, v125
    v_sub_f32 v32, 0, v121
    v_sub_f32 v33, 0, v121
    v_sub_f32 v34, 0, v121
    v_sub_f32 v35, 0, v121
    v_sub_f32 v36, 0, v121
    v_sub_f32 v37, 0, v121
    v_sub_f32 v38, 0, v121
    v_sub_f32 v39, 0, v121
    v_sub_f32 v40, 0, v121
    v_sub_f32 v41, 0, v121
    v_sub_f32 v42, 0, v121
    v_sub_f32 v43, 0, v121
    v_sub_f32 v44, 0, v121
    v_sub_f32 v45, 0, v121
    v_sub_f32 v46, 0, v121
    v_sub_f32 v47, 0, v121
    v_max3_f32 v124, v16, v17, v18
    v_max3_f32 v125, v19, v20, v21
    v_max3_f32 v126, v22, v23, v24
    v_max3_f32 v127, v25, v26, v27
    v_max3_f32 v128, v28, v29, v30
    v_max3_f32 v124, v124, v125, v31
    v_max3_f32 v126, v126, v127, v128
    v_max_f32 v124, v124, v126
    v_mov_b32 v125, v124
    s_nop 1
    v_permlane32_swap_b32 v124, v125
    s_nop 1
    v_max_f32 v122, v124, v125
    v_mfma_f32_32x32x16_bf16 v[0:15], a[0:3], a[96:99], v[32:47]
    v_mfma_f32_32x32x16_bf16 v[0:15], a[4:7], a[100:103], v[0:15]
    v_sub_f32 v48, 0, v122
    v_sub_f32 v49, 0, v122
    v_sub_f32 v50, 0, v122
    v_sub_f32 v51, 0, v122
    v_sub_f32 v52, 0, v122
    v_sub_f32 v53, 0, v122
    v_sub_f32 v54, 0, v122
    v_sub_f32 v55, 0, v122
    v_sub_f32 v56, 0, v122
    v_sub_f32 v57, 0, v122
    v_sub_f32 v58, 0, v122
    v_sub_f32 v59, 0, v122
    v_sub_f32 v60, 0, v122
    v_sub_f32 v61, 0, v122
    v_sub_f32 v62, 0, v122
    v_sub_f32 v63, 0, v122
    s_nop 0
L_att:
    v_exp_f32 v0, v0
    v_mfma_f32_32x32x16_bf16 v[16:31], a[0:3], a[104:107], v[48:63]
    v_exp_f32 v1, v1
    v_exp_f32 v2, v2
    v_exp_f32 v3, v3
    v_cvt_pk_bf16_f32 v96, v0, v1
    v_mfma_f32_32x32x16_bf16 v[16:31], a[4:7], a[108:111], v[16:31]
    v_cvt_pk_bf16_f32 v97, v2, v3
    v_exp_f32 v4, v4
    v_exp_f32 v5, v5
    v_exp_f32 v6, v6
    v_exp_f32 v7, v7
    v_mfma_f32_32x32x16_bf16 a[48:63], a[24:27], v[104:107], a[48:63]
    v_cvt_pk_bf16_f32 v98, v4, v5
    v_cvt_pk_bf16_f32 v99, v6, v7
    v_exp_f32 v8, v8
    v_exp_f32 v9, v9
    v_exp_f32 v10, v10
    v_mfma_f32_32x32x16_bf16 a[48:63], a[28:31], v[108:111], a[48:63]
    v_exp_f32 v11, v11
    v_cvt_pk_bf16_f32 v100, v8, v9
    v_cvt_pk_bf16_f32 v101, v10, v11
    v_exp_f32 v12, v12
    v_exp_f32 v13, v13
    v_smfmac_f32_16x16x64_bf16 a[68:71], v[112:115], v[104:111], v116
    v_exp_f32 v14, v14
    v_exp_f32 v15, v15
    v_cvt_pk_bf16_f32 v102, v12, v13
    v_cvt_pk_bf16_f32 v103, v14, v15
    s_waitcnt lgkmcnt(0)
    v_exp_f32 v16, v16
    v_mfma_f32_32x32x16_bf16 v[0:15], a[8:11], a[96:99], v[32:47]
    ds_read_b128 a[0:3], v117 offset:8192
    v_exp_f32 v17, v17
    v_exp_f32 v18, v18
    v_exp_f32 v19, v19
    v_cvt_pk_bf16_f32 v104, v16, v17
    v_mfma_f32_32x32x16_bf16 v[0:15], a[12:15], a[100:103], v[0:15]
    ds_read_b128 a[4:7], v117 offset:9216
    v_cvt_pk_bf16_f32 v105, v18, v19
    v_exp_f32 v20, v20
    v_exp_f32 v21, v21
    v_exp_f32 v22, v22
    v_exp_f32 v23, v23
    v_mfma_f32_32x32x16_bf16 a[32:47], a[16:19], v[96:99], a[32:47]
    ds_read_b128 a[24:27], v117 offset:6144
    v_cvt_pk_bf16_f32 v106, v20, v21
    v_cvt_pk_bf16_f32 v107, v22, v23
    v_exp_f32 v24, v24
    v_exp_f32 v25, v25
    v_exp_f32 v26, v26
    v_mfma_f32_32x32x16_bf16 a[32:47], a[20:23], v[100:103], a[32:47]
    ds_read_b128 a[28:31], v117 offset:7168
    v_exp_f32 v27, v27
    v_cvt_pk_bf16_f32 v108, v24, v25
    v_cvt_pk_bf16_f32 v109, v26, v27
    v_exp_f32 v28, v28
    v_exp_f32 v29, v29
    v_smfmac_f32_16x16x64_bf16 a[64:67], v[112:115], v[96:103], v116
    v_exp_f32 v30, v30
    v_exp_f32 v31, v31
    v_cvt_pk_bf16_f32 v110, v28, v29
    v_cvt_pk_bf16_f32 v111, v30, v31
    v_exp_f32 v0, v0
    v_mfma_f32_32x32x16_bf16 v[16:31], a[8:11], a[104:107], v[48:63]
    v_exp_f32 v1, v1
    v_exp_f32 v2, v2
    v_exp_f32 v3, v3
    v_cvt_pk_bf16_f32 v96, v0, v1
    v_mfma_f32_32x32x16_bf16 v[16:31], a[12:15], a[108:111], v[16:31]
    v_cvt_pk_bf16_f32 v97, v2, v3
    v_exp_f32 v4, v4
    v_exp_f32 v5, v5
    v_exp_f32 v6, v6
    v_exp_f32 v7, v7
    v_mfma_f32_32x32x16_bf16 a[48:63], a[16:19], v[104:107], a[48:63]
    v_cvt_pk_bf16_f32 v98, v4, v5
    v_cvt_pk_bf16_f32 v99, v6, v7
    v_exp_f32 v8, v8
    v_exp_f32 v9, v9
    v_exp_f32 v10, v10
    v_mfma_f32_32x32x16_bf16 a[48:63], a[20:23], v[108:111], a[48:63]
    v_exp_f32 v11, v11
    v_cvt_pk_bf16_f32 v100, v8, v9
    v_cvt_pk_bf16_f32 v101, v10, v11
    v_exp_f32 v12, v12
    v_exp_f32 v13, v13
    v_smfmac_f32_16x16x64_bf16 a[68:71], v[112:115], v[104:111], v116
    v_exp_f32 v14, v14
    v_exp_f32 v15, v15
    v_cvt_pk_bf16_f32 v102, v12, v13
    v_cvt_pk_bf16_f32 v103, v14, v15
    s_waitcnt lgkmcnt(0)
    v_exp_f32 v16, v16
    v_mfma_f32_32x32x16_bf16 v[0:15], a[0:3], a[96:99], v[32:47]
    ds_read_b128 a[8:11], v117 offset:12288
    v_exp_f32 v17, v17
    v_exp_f32 v18, v18
    v_exp_f32 v19, v19
    v_cvt_pk_bf16_f32 v104, v16, v17
    v_mfma_f32_32x32x16_bf16 v[0:15], a[4:7], a[100:103], v[0:15]
    ds_read_b128 a[12:15], v117 offset:13312
    v_cvt_pk_bf16_f32 v105, v18, v19
    v_exp_f32 v20, v20
    v_exp_f32 v21, v21
    v_exp_f32 v22, v22
    v_exp_f32 v23, v23
    v_mfma_f32_32x32x16_bf16 a[32:47], a[24:27], v[96:99], a[32:47]
    ds_read_b128 a[16:19], v117 offset:10240
    v_cvt_pk_bf16_f32 v106, v20, v21
    v_cvt_pk_bf16_f32 v107, v22, v23
    v_exp_f32 v24, v24
    v_exp_f32 v25, v25
    v_exp_f32 v26, v26
    v_mfma_f32_32x32x16_bf16 a[32:47], a[28:31], v[100:103], a[32:47]
    ds_read_b128 a[20:23], v117 offset:11264
    v_exp_f32 v27, v27
    v_cvt_pk_bf16_f32 v108, v24, v25
    v_cvt_pk_bf16_f32 v109, v26, v27
    v_exp_f32 v28, v28
    v_exp_f32 v29, v29
    v_smfmac_f32_16x16x64_bf16 a[64:67], v[112:115], v[96:103], v116
    v_exp_f32 v30, v30
    v_exp_f32 v31, v31
    v_cvt_pk_bf16_f32 v110, v28, v29
    v_cvt_pk_bf16_f32 v111, v30, v31
    v_exp_f32 v0, v0
    v_mfma_f32_32x32x16_bf16 v[16:31], a[0:3], a[104:107], v[48:63]
    v_exp_f32 v1, v1
    v_exp_f32 v2, v2
    v_exp_f32 v3, v3
    v_cvt_pk_bf16_f32 v96, v0, v1
    v_mfma_f32_32x32x16_bf16 v[16:31], a[4:7], a[108:111], v[16:31]
    v_cvt_pk_bf16_f32 v97, v2, v3
    v_exp_f32 v4, v4
    v_exp_f32 v5, v5
    v_exp_f32 v6, v6
    v_exp_f32 v7, v7
    v_mfma_f32_32x32x16_bf16 a[48:63], a[24:27], v[104:107], a[48:63]
    v_cvt_pk_bf16_f32 v98, v4, v5
    v_cvt_pk_bf16_f32 v99, v6, v7
    v_exp_f32 v8, v8
    v_exp_f32 v9, v9
    v_exp_f32 v10, v10
    v_mfma_f32_32x32x16_bf16 a[48:63], a[28:31], v[108:111], a[48:63]
    v_exp_f32 v11, v11
    v_cvt_pk_bf16_f32 v100, v8, v9
    v_cvt_pk_bf16_f32 v101, v10, v11
    v_exp_f32 v12, v12
    v_exp_f32 v13, v13
    v_smfmac_f32_16x16x64_bf16 a[68:71], v[112:115], v[104:111], v116
    v_exp_f32 v14, v14
    v_exp_f32 v15, v15
    v_cvt_pk_bf16_f32 v102, v12, v13
    v_cvt_pk_bf16_f32 v103, v14, v15
    s_waitcnt lgkmcnt(0)
    s_barrier
    v_exp_f32 v16, v16
    v_mfma_f32_32x32x16_bf16 v[0:15], a[8:11], a[96:99], v[32:47]
    ds_read_b128 a[0:3], v118 offset:0
    v_exp_f32 v17, v17
    v_exp_f32 v18, v18
    v_exp_f32 v19, v19
    v_cvt_pk_bf16_f32 v104, v16, v17
    v_mfma_f32_32x32x16_bf16 v[0:15], a[12:15], a[100:103], v[0:15]
    ds_read_b128 a[4:7], v118 offset:1024
    v_cvt_pk_bf16_f32 v105, v18, v19
    v_exp_f32 v20, v20
    v_exp_f32 v21, v21
    v_exp_f32 v22, v22
    v_exp_f32 v23, v23
    v_mfma_f32_32x32x16_bf16 a[32:47], a[16:19], v[96:99], a[32:47]
    ds_read_b128 a[24:27], v117 offset:14336
    v_cvt_pk_bf16_f32 v106, v20, v21
    v_cvt_pk_bf16_f32 v107, v22, v23
    v_exp_f32 v24, v24
    v_exp_f32 v25, v25
    v_exp_f32 v26, v26
    v_mfma_f32_32x32x16_bf16 a[32:47], a[20:23], v[100:103], a[32:47]
    ds_read_b128 a[28:31], v117 offset:15360
    v_exp_f32 v27, v27
    v_cvt_pk_bf16_f32 v108, v24, v25
    v_cvt_pk_bf16_f32 v109, v26, v27
    v_exp_f32 v28, v28
    v_exp_f32 v29, v29
    v_smfmac_f32_16x16x64_bf16 a[64:67], v[112:115], v[96:103], v116
    v_exp_f32 v30, v30
    v_exp_f32 v31, v31
    v_cvt_pk_bf16_f32 v110, v28, v29
    v_cvt_pk_bf16_f32 v111, v30, v31
    v_exp_f32 v0, v0
    v_mfma_f32_32x32x16_bf16 v[16:31], a[8:11], a[104:107], v[48:63]
    s_add_u32 s30, s30, 32768
    s_cmp_ge_u32 s30, s31
    s_cselect_b32 s30, 0, s30
    v_exp_f32 v1, v1
    v_exp_f32 v2, v2
    v_exp_f32 v3, v3
    v_cvt_pk_bf16_f32 v96, v0, v1
    v_mfma_f32_32x32x16_bf16 v[16:31], a[12:15], a[108:111], v[16:31]
    v_cvt_pk_bf16_f32 v97, v2, v3
    v_exp_f32 v4, v4
    v_exp_f32 v5, v5
    v_exp_f32 v6, v6
    v_exp_f32 v7, v7
    v_mfma_f32_32x32x16_bf16 a[48:63], a[16:19], v[104:107], a[48:63]
    v_cvt_pk_bf16_f32 v98, v4, v5
    v_cvt_pk_bf16_f32 v99, v6, v7
    v_exp_f32 v8, v8
    v_exp_f32 v9, v9
    v_exp_f32 v10, v10
    v_mfma_f32_32x32x16_bf16 a[48:63], a[20:23], v[108:111], a[48:63]
    v_exp_f32 v11, v11
    v_cvt_pk_bf16_f32 v100, v8, v9
    v_cvt_pk_bf16_f32 v101, v10, v11
    v_exp_f32 v12, v12
    v_exp_f32 v13, v13
    v_smfmac_f32_16x16x64_bf16 a[68:71], v[112:115], v[104:111], v116
    v_exp_f32 v14, v14
    v_exp_f32 v15, v15
    v_cvt_pk_bf16_f32 v102, v12, v13
    v_cvt_pk_bf16_f32 v103, v14, v15
    s_waitcnt lgkmcnt(0)
    v_exp_f32 v16, v16
    v_mfma_f32_32x32x16_bf16 v[0:15], a[0:3], a[96:99], v[32:47]
    ds_read_b128 a[8:11], v118 offset:4096
    v_exp_f32 v17, v17
    v_exp_f32 v18, v18
    v_exp_f32 v19, v19
    v_cvt_pk_bf16_f32 v104, v16, v17
    v_mfma_f32_32x32x16_bf16 v[0:15], a[4:7], a[100:103], v[0:15]
    ds_read_b128 a[12:15], v118 offset:5120
    v_cvt_pk_bf16_f32 v105, v18, v19
    v_exp_f32 v20, v20
    v_exp_f32 v21, v21
    v_exp_f32 v22, v22
    v_exp_f32 v23, v23
    v_mfma_f32_32x32x16_bf16 a[32:47], a[24:27], v[96:99], a[32:47]
    ds_read_b128 a[16:19], v118 offset:2048
    v_cvt_pk_bf16_f32 v106, v20, v21
    v_cvt_pk_bf16_f32 v107, v22, v23
    v_exp_f32 v24, v24
    v_exp_f32 v25, v25
    v_exp_f32 v26, v26
    v_mfma_f32_32x32x16_bf16 a[32:47], a[28:31], v[100:103], a[32:47]
    ds_read_b128 a[20:23], v118 offset:3072
    v_exp_f32 v27, v27
    v_cvt_pk_bf16_f32 v108, v24, v25
    v_cvt_pk_bf16_f32 v109, v26, v27
    v_exp_f32 v28, v28
    v_exp_f32 v29, v29
    v_smfmac_f32_16x16x64_bf16 a[64:67], v[112:115], v[96:103], v116
    v_mov_b32 v117, v118
    v_add_u32 v118, s30, v120
    s_add_u32 s25, s25, 1
    s_cmp_lg_u32 s25, s33
    v_exp_f32 v30, v30
    v_exp_f32 v31, v31
    v_cvt_pk_bf16_f32 v110, v28, v29
    v_cvt_pk_bf16_f32 v111, v30, v31
    s_cbranch_scc1 L_att
    s_cmp_eq_u32 s25, 16
    s_cbranch_scc1 L_tail
    s_waitcnt vmcnt(0)
    v_mov_b32 v139, s32
    v_min_u32 v140, 1, v143
    v_lshlrev_b32 v140, 30, v140
    buffer_store_dword v139, v140, s[12:15], s98 offen sc1
    s_mov_b32 s33, 16
    s_mov_b32 s31, 131072
    s_branch L_att
L_fb_a:
    s_add_u32 s36, s94, 0
    s_lshl_b32 s37, s95, 18
    s_add_u32 s37, s37, 1048576
    s_lshl_b32 s38, s36, 12
    s_add_u32 s38, s38, s37
    s_add_u32 s37, s37, 8388608
    s_min_u32 s36, s36, 8
    s_add_u32 s36, s36, 1
    s_mov_b32 s35, -4096
    s_cmp_lg_u32 s93, 0
    s_cselect_b32 s34, s37, s38
    s_cselect_b32 s35, 4096, s35
    s_cselect_b32 s99, 64, s36
    s_mov_b32 s100, 0
    v_mov_b32 v121, 0xff800000
    s_cbranch_scc1 L_fbq_a
    v_accvgpr_mov_b32 a72, a80
    v_accvgpr_mov_b32 a73, a81
    v_accvgpr_mov_b32 a74, a82
    v_accvgpr_mov_b32 a75, a83
    v_accvgpr_mov_b32 a76, a84
    v_accvgpr_mov_b32 a77, a85
    v_accvgpr_mov_b32 a78, a86
    v_accvgpr_mov_b32 a79, a87
    s_branch L_fbq_a2
L_fbq_a:
    v_accvgpr_mov_b32 a72, a96
    v_accvgpr_mov_b32 a73, a97
    v_accvgpr_mov_b32 a74, a98
    v_accvgpr_mov_b32 a75, a99
    v_accvgpr_mov_b32 a76, a100
    v_accvgpr_mov_b32 a77, a101
    v_accvgpr_mov_b32 a78, a102
    v_accvgpr_mov_b32 a79, a103
L_fbq_a2:
    v_accvgpr_write_b32 a32, 0
    v_accvgpr_write_b32 a33, 0
    v_accvgpr_write_b32 a34, 0
    v_accvgpr_write_b32 a35, 0
    v_accvgpr_write_b32 a36, 0
    v_accvgpr_write_b32 a37, 0
    v_accvgpr_write_b32 a38, 0
    v_accvgpr_write_b32 a39, 0
    v_accvgpr_write_b32 a40, 0
    v_accvgpr_write_b32 a41, 0
    v_accvgpr_write_b32 a42, 0
    v_accvgpr_write_b32 a43, 0
    v_accvgpr_write_b32 a44, 0
    v_accvgpr_write_b32 a45, 0
    v_accvgpr_write_b32 a46, 0
    v_accvgpr_write_b32 a47, 0
    v_accvgpr_write_b32 a64, 0
    v_accvgpr_write_b32 a65, 0
    v_accvgpr_write_b32 a66, 0
    v_accvgpr_write_b32 a67, 0
L_fbl_a:
    buffer_load_dwordx4 a[0:3], v142, s[12:15], s34 offen sc1
    buffer_load_dwordx4 a[4:7], v142, s[12:15], s34 offen offset:1024 sc1
    buffer_load_dwordx4 a[16:19], v142, s[12:15], s34 offen offset:2048 sc1
    buffer_load_dwordx4 a[20:23], v142, s[12:15], s34 offen offset:3072 sc1
    s_mov_b32 s44, 0
    s_mov_b32 s45, 0
    s_cmp_eq_u32 s100, 0
    s_cselect_b32 s44, 0xff800000, s44
    s_cmp_eq_u32 s100, 8
    s_cselect_b32 s44, 0xff800000, s44
    s_cselect_b32 s45, 0xff800000, s45
    s_cmp_lg_u32 s93, 0
    s_cselect_b32 s44, 0, s44
    s_cselect_b32 s45, 0, s45
    v_subrev_u32 v64, 0, v119
    v_ashrrev_i32 v64, 31, v64
    v_and_b32 v64, s44, v64
    v_xor_b32 v64, s45, v64
    v_subrev_u32 v65, 1, v119
    v_ashrrev_i32 v65, 31, v65
    v_and_b32 v65, s44, v65
    v_xor_b32 v65, s45, v65
    v_subrev_u32 v66, 2, v119
    v_ashrrev_i32 v66, 31, v66
    v_and_b32 v66, s44, v66
    v_xor_b32 v66, s45, v66
    v_subrev_u32 v67, 3, v119
    v_ashrrev_i32 v67, 31, v67
    v_and_b32 v67, s44, v67
    v_xor_b32 v67, s45, v67
    v_subrev_u32 v68, 16, v119
    v_ashrrev_i32 v68, 31, v68
    v_and_b32 v68, s44, v68
    v_xor_b32 v68, s45, v68
    v_subrev_u32 v69, 17, v119
    v_ashrrev_i32 v69, 31, v69
    v_and_b32 v69, s44, v69
    v_xor_b32 v69, s45, v69
    v_subrev_u32 v70, 18, v119
    v_ashrrev_i32 v70, 31, v70
    v_and_b32 v70, s44, v70
    v_xor_b32 v70, s45, v70
    v_subrev_u32 v71, 19, v119
    v_ashrrev_i32 v71, 31, v71
    v_and_b32 v71, s44, v71
    v_xor_b32 v71, s45, v71
    v_subrev_u32 v72, 4, v119
    v_ashrrev_i32 v72, 31, v72
    v_and_b32 v72, s44, v72
    v_xor_b32 v72, s45, v72
    v_subrev_u32 v73, 5, v119
    v_ashrrev_i32 v73, 31, v73
    v_and_b32 v73, s44, v73
    v_xor_b32 v73, s45, v73
    v_subrev_u32 v74, 6, v119
    v_ashrrev_i32 v74, 31, v74
    v_and_b32 v74, s44, v74
    v_xor_b32 v74, s45, v74
    v_subrev_u32 v75, 7, v119
    v_ashrrev_i32 v75, 31, v75
    v_and_b32 v75, s44, v75
    v_xor_b32 v75, s45, v75
    v_subrev_u32 v76, 20, v119
    v_ashrrev_i32 v76, 31, v76
    v_and_b32 v76, s44, v76
    v_xor_b32 v76, s45, v76
    v_subrev_u32 v77, 21, v119
    v_ashrrev_i32 v77, 31, v77
    v_and_b32 v77, s44, v77
    v_xor_b32 v77, s45, v77
    v_subrev_u32 v78, 22, v119
    v_ashrrev_i32 v78, 31, v78
    v_and_b32 v78, s44, v78
    v_xor_b32 v78, s45, v78
    v_subrev_u32 v79, 23, v119
    v_ashrrev_i32 v79, 31, v79
    v_and_b32 v79, s44, v79
    v_xor_b32 v79, s45, v79
    s_waitcnt vmcnt(0)
    v_mfma_f32_32x32x16_bf16 v[0:15], a[0:3], a[72:75], v[64:79]
    v_mfma_f32_32x32x16_bf16 v[0:15], a[4:7], a[76:79], v[0:15]
    s_nop 15
    v_max3_f32 v124, v0, v1, v2
    v_max3_f32 v125, v3, v4, v5
    v_max3_f32 v126, v6, v7, v8
    v_max3_f32 v127, v9, v10, v11
    v_max3_f32 v128, v12, v13, v14
    v_max3_f32 v124, v124, v125, v15
    v_max3_f32 v126, v126, v127, v128
    v_max_f32 v124, v124, v126
    v_mov_b32 v125, v124
    s_nop 1
    v_permlane32_swap_b32 v124, v125
    s_nop 1
    v_max_f32 v129, v124, v125
    v_max_f32 v129, v129, v121
    v_sub_f32 v130, v121, v129
    v_exp_f32 v130, v130
    v_mov_b32 v121, v129
    v_accvgpr_read_b32 v132, a32
    v_mul_f32 v132, v132, v130
    v_accvgpr_write_b32 a32, v132
    v_accvgpr_read_b32 v132, a33
    v_mul_f32 v132, v132, v130
    v_accvgpr_write_b32 a33, v132
    v_accvgpr_read_b32 v132, a34
    v_mul_f32 v132, v132, v130
    v_accvgpr_write_b32 a34, v132
    v_accvgpr_read_b32 v132, a35
    v_mul_f32 v132, v132, v130
    v_accvgpr_write_b32 a35, v132
    v_accvgpr_read_b32 v132, a36
    v_mul_f32 v132, v132, v130
    v_accvgpr_write_b32 a36, v132
    v_accvgpr_read_b32 v132, a37
    v_mul_f32 v132, v132, v130
    v_accvgpr_write_b32 a37, v132
    v_accvgpr_read_b32 v132, a38
    v_mul_f32 v132, v132, v130
    v_accvgpr_write_b32 a38, v132
    v_accvgpr_read_b32 v132, a39
    v_mul_f32 v132, v132, v130
    v_accvgpr_write_b32 a39, v132
    v_accvgpr_read_b32 v132, a40
    v_mul_f32 v132, v132, v130
    v_accvgpr_write_b32 a40, v132
    v_accvgpr_read_b32 v132, a41
    v_mul_f32 v132, v132, v130
    v_accvgpr_write_b32 a41, v132
    v_accvgpr_read_b32 v132, a42
    v_mul_f32 v132, v132, v130
    v_accvgpr_write_b32 a42, v132
    v_accvgpr_read_b32 v132, a43
    v_mul_f32 v132, v132, v130
    v_accvgpr_write_b32 a43, v132
    v_accvgpr_read_b32 v132, a44
    v_mul_f32 v132, v132, v130
    v_accvgpr_write_b32 a44, v132
    v_accvgpr_read_b32 v132, a45
    v_mul_f32 v132, v132, v130
    v_accvgpr_write_b32 a45, v132
    v_accvgpr_read_b32 v132, a46
    v_mul_f32 v132, v132, v130
    v_accvgpr_write_b32 a46, v132
    v_accvgpr_read_b32 v132, a47
    v_mul_f32 v132, v132, v130
    v_accvgpr_write_b32 a47, v132
    v_accvgpr_read_b32 v132, a64
    v_mul_f32 v132, v132, v130
    v_accvgpr_write_b32 a64, v132
    v_accvgpr_read_b32 v132, a65
    v_mul_f32 v132, v132, v130
    v_accvgpr_write_b32 a65, v132
    v_accvgpr_read_b32 v132, a66
    v_mul_f32 v132, v132, v130
    v_accvgpr_write_b32 a66, v132
    v_accvgpr_read_b32 v132, a67
    v_mul_f32 v132, v132, v130
    v_accvgpr_write_b32 a67, v132
    v_sub_f32 v0, v0, v121
    v_sub_f32 v1, v1, v121
    v_sub_f32 v2, v2, v121
    v_sub_f32 v3, v3, v121
    v_sub_f32 v4, v4, v121
    v_sub_f32 v5, v5, v121
    v_sub_f32 v6, v6, v121
    v_sub_f32 v7, v7, v121
    v_sub_f32 v8, v8, v121
    v_sub_f32 v9, v9, v121
    v_sub_f32 v10, v10, v121
    v_sub_f32 v11, v11, v121
    v_sub_f32 v12, v12, v121
    v_sub_f32 v13, v13, v121
    v_sub_f32 v14, v14, v121
    v_sub_f32 v15, v15, v121
    v_exp_f32 v0, v0
    v_exp_f32 v1, v1
    v_exp_f32 v2, v2
    v_exp_f32 v3, v3
    v_exp_f32 v4, v4
    v_exp_f32 v5, v5
    v_exp_f32 v6, v6
    v_exp_f32 v7, v7
    v_exp_f32 v8, v8
    v_exp_f32 v9, v9
    v_exp_f32 v10, v10
    v_exp_f32 v11, v11
    v_exp_f32 v12, v12
    v_exp_f32 v13, v13
    v_exp_f32 v14, v14
    v_exp_f32 v15, v15
    s_nop 0
    v_cvt_pk_bf16_f32 v96, v0, v1
    v_cvt_pk_bf16_f32 v97, v2, v3
    v_cvt_pk_bf16_f32 v98, v4, v5
    v_cvt_pk_bf16_f32 v99, v6, v7
    v_cvt_pk_bf16_f32 v100, v8, v9
    v_cvt_pk_bf16_f32 v101, v10, v11
    v_cvt_pk_bf16_f32 v102, v12, v13
    v_cvt_pk_bf16_f32 v103, v14, v15
    s_nop 1
    v_mfma_f32_32x32x16_bf16 a[32:47], a[16:19], v[96:99], a[32:47]
    v_mfma_f32_32x32x16_bf16 a[32:47], a[20:23], v[100:103], a[32:47]
    v_smfmac_f32_16x16x64_bf16 a[64:67], v[112:115], v[96:103], v116
    s_add_u32 s34, s34, s35
    s_add_u32 s100, s100, 1
    s_cmp_lt_u32 s100, s99
    s_nop 15
    s_cbranch_scc1 L_fbl_a
    v_accvgpr_read_b32 v32, a32
    v_accvgpr_read_b32 v33, a33
    v_accvgpr_read_b32 v34, a34
    v_accvgpr_read_b32 v35, a35
    v_accvgpr_read_b32 v36, a36
    v_accvgpr_read_b32 v37, a37
    v_accvgpr_read_b32 v38, a38
    v_accvgpr_read_b32 v39, a39
    v_accvgpr_read_b32 v40, a40
    v_accvgpr_read_b32 v41, a41
    v_accvgpr_read_b32 v42, a42
    v_accvgpr_read_b32 v43, a43
    v_accvgpr_read_b32 v44, a44
    v_accvgpr_read_b32 v45, a45
    v_accvgpr_read_b32 v46, a46
    v_accvgpr_read_b32 v47, a47
    v_accvgpr_read_b32 v124, a64
    v_accvgpr_read_b32 v125, a65
    v_add_f32 v124, v124, v125
    s_mov_b32 s41, 1
    s_branch L_st_a
L_fb_b:
    s_add_u32 s36, s94, 1
    s_lshl_b32 s37, s95, 18
    s_add_u32 s37, s37, 1048576
    s_lshl_b32 s38, s36, 12
    s_add_u32 s38, s38, s37
    s_add_u32 s37, s37, 8388608
    s_min_u32 s36, s36, 8
    s_add_u32 s36, s36, 1
    s_mov_b32 s35, -4096
    s_cmp_lg_u32 s93, 0
    s_cselect_b32 s34, s37, s38
    s_cselect_b32 s35, 4096, s35
    s_cselect_b32 s99, 64, s36
    s_mov_b32 s100, 0
    v_mov_b32 v122, 0xff800000
    s_cbranch_scc1 L_fbq_b
    v_accvgpr_mov_b32 a72, a88
    v_accvgpr_mov_b32 a73, a89
    v_accvgpr_mov_b32 a74, a90
    v_accvgpr_mov_b32 a75, a91
    v_accvgpr_mov_b32 a76, a92
    v_accvgpr_mov_b32 a77, a93
    v_accvgpr_mov_b32 a78, a94
    v_accvgpr_mov_b32 a79, a95
    s_branch L_fbq_b2
L_fbq_b:
    v_accvgpr_mov_b32 a72, a104
    v_accvgpr_mov_b32 a73, a105
    v_accvgpr_mov_b32 a74, a106
    v_accvgpr_mov_b32 a75, a107
    v_accvgpr_mov_b32 a76, a108
    v_accvgpr_mov_b32 a77, a109
    v_accvgpr_mov_b32 a78, a110
    v_accvgpr_mov_b32 a79, a111
L_fbq_b2:
    v_accvgpr_write_b32 a48, 0
    v_accvgpr_write_b32 a49, 0
    v_accvgpr_write_b32 a50, 0
    v_accvgpr_write_b32 a51, 0
    v_accvgpr_write_b32 a52, 0
    v_accvgpr_write_b32 a53, 0
    v_accvgpr_write_b32 a54, 0
    v_accvgpr_write_b32 a55, 0
    v_accvgpr_write_b32 a56, 0
    v_accvgpr_write_b32 a57, 0
    v_accvgpr_write_b32 a58, 0
    v_accvgpr_write_b32 a59, 0
    v_accvgpr_write_b32 a60, 0
    v_accvgpr_write_b32 a61, 0
    v_accvgpr_write_b32 a62, 0
    v_accvgpr_write_b32 a63, 0
    v_accvgpr_write_b32 a68, 0
    v_accvgpr_write_b32 a69, 0
    v_accvgpr_write_b32 a70, 0
    v_accvgpr_write_b32 a71, 0
L_fbl_b:
    buffer_load_dwordx4 a[0:3], v142, s[12:15], s34 offen sc1
    buffer_load_dwordx4 a[4:7], v142, s[12:15], s34 offen offset:1024 sc1
    buffer_load_dwordx4 a[16:19], v142, s[12:15], s34 offen offset:2048 sc1
    buffer_load_dwordx4 a[20:23], v142, s[12:15], s34 offen offset:3072 sc1
    s_mov_b32 s44, 0
    s_mov_b32 s45, 0
    s_cmp_eq_u32 s100, 0
    s_cselect_b32 s44, 0xff800000, s44
    s_cmp_eq_u32 s100, 8
    s_cselect_b32 s44, 0xff800000, s44
    s_cselect_b32 s45, 0xff800000, s45
    s_cmp_lg_u32 s93, 0
    s_cselect_b32 s44, 0, s44
    s_cselect_b32 s45, 0, s45
    v_subrev_u32 v80, 0, v119
    v_ashrrev_i32 v80, 31, v80
    v_and_b32 v80, s44, v80
    v_xor_b32 v80, s45, v80
    v_subrev_u32 v81, 1, v119
    v_ashrrev_i32 v81, 31, v81
    v_and_b32 v81, s44, v81
    v_xor_b32 v81, s45, v81
    v_subrev_u32 v82, 2, v119
    v_ashrrev_i32 v82, 31, v82
    v_and_b32 v82, s44, v82
    v_xor_b32 v82, s45, v82
    v_subrev_u32 v83, 3, v119
    v_ashrrev_i32 v83, 31, v83
    v_and_b32 v83, s44, v83
    v_xor_b32 v83, s45, v83
    v_subrev_u32 v84, 16, v119
    v_ashrrev_i32 v84, 31, v84
    v_and_b32 v84, s44, v84
    v_xor_b32 v84, s45, v84
    v_subrev_u32 v85, 17, v119
    v_ashrrev_i32 v85, 31, v85
    v_and_b32 v85, s44, v85
    v_xor_b32 v85, s45, v85
    v_subrev_u32 v86, 18, v119
    v_ashrrev_i32 v86, 31, v86
    v_and_b32 v86, s44, v86
    v_xor_b32 v86, s45, v86
    v_subrev_u32 v87, 19, v119
    v_ashrrev_i32 v87, 31, v87
    v_and_b32 v87, s44, v87
    v_xor_b32 v87, s45, v87
    v_subrev_u32 v88, 4, v119
    v_ashrrev_i32 v88, 31, v88
    v_and_b32 v88, s44, v88
    v_xor_b32 v88, s45, v88
    v_subrev_u32 v89, 5, v119
    v_ashrrev_i32 v89, 31, v89
    v_and_b32 v89, s44, v89
    v_xor_b32 v89, s45, v89
    v_subrev_u32 v90, 6, v119
    v_ashrrev_i32 v90, 31, v90
    v_and_b32 v90, s44, v90
    v_xor_b32 v90, s45, v90
    v_subrev_u32 v91, 7, v119
    v_ashrrev_i32 v91, 31, v91
    v_and_b32 v91, s44, v91
    v_xor_b32 v91, s45, v91
    v_subrev_u32 v92, 20, v119
    v_ashrrev_i32 v92, 31, v92
    v_and_b32 v92, s44, v92
    v_xor_b32 v92, s45, v92
    v_subrev_u32 v93, 21, v119
    v_ashrrev_i32 v93, 31, v93
    v_and_b32 v93, s44, v93
    v_xor_b32 v93, s45, v93
    v_subrev_u32 v94, 22, v119
    v_ashrrev_i32 v94, 31, v94
    v_and_b32 v94, s44, v94
    v_xor_b32 v94, s45, v94
    v_subrev_u32 v95, 23, v119
    v_ashrrev_i32 v95, 31, v95
    v_and_b32 v95, s44, v95
    v_xor_b32 v95, s45, v95
    s_waitcnt vmcnt(0)
    v_mfma_f32_32x32x16_bf16 v[16:31], a[0:3], a[72:75], v[80:95]
    v_mfma_f32_32x32x16_bf16 v[16:31], a[4:7], a[76:79], v[16:31]
    s_nop 15
    v_max3_f32 v124, v16, v17, v18
    v_max3_f32 v125, v19, v20, v21
    v_max3_f32 v126, v22, v23, v24
    v_max3_f32 v127, v25, v26, v27
    v_max3_f32 v128, v28, v29, v30
    v_max3_f32 v124, v124, v125, v31
    v_max3_f32 v126, v126, v127, v128
    v_max_f32 v124, v124, v126
    v_mov_b32 v125, v124
    s_nop 1
    v_permlane32_swap_b32 v124, v125
    s_nop 1
    v_max_f32 v129, v124, v125
    v_max_f32 v129, v129, v122
    v_sub_f32 v130, v122, v129
    v_exp_f32 v130, v130
    v_mov_b32 v122, v129
    v_accvgpr_read_b32 v132, a48
    v_mul_f32 v132, v132, v130
    v_accvgpr_write_b32 a48, v132
    v_accvgpr_read_b32 v132, a49
    v_mul_f32 v132, v132, v130
    v_accvgpr_write_b32 a49, v132
    v_accvgpr_read_b32 v132, a50
    v_mul_f32 v132, v132, v130
    v_accvgpr_write_b32 a50, v132
    v_accvgpr_read_b32 v132, a51
    v_mul_f32 v132, v132, v130
    v_accvgpr_write_b32 a51, v132
    v_accvgpr_read_b32 v132, a52
    v_mul_f32 v132, v132, v130
    v_accvgpr_write_b32 a52, v132
    v_accvgpr_read_b32 v132, a53
    v_mul_f32 v132, v132, v130
    v_accvgpr_write_b32 a53, v132
    v_accvgpr_read_b32 v132, a54
    v_mul_f32 v132, v132, v130
    v_accvgpr_write_b32 a54, v132
    v_accvgpr_read_b32 v132, a55
    v_mul_f32 v132, v132, v130
    v_accvgpr_write_b32 a55, v132
    v_accvgpr_read_b32 v132, a56
    v_mul_f32 v132, v132, v130
    v_accvgpr_write_b32 a56, v132
    v_accvgpr_read_b32 v132, a57
    v_mul_f32 v132, v132, v130
    v_accvgpr_write_b32 a57, v132
    v_accvgpr_read_b32 v132, a58
    v_mul_f32 v132, v132, v130
    v_accvgpr_write_b32 a58, v132
    v_accvgpr_read_b32 v132, a59
    v_mul_f32 v132, v132, v130
    v_accvgpr_write_b32 a59, v132
    v_accvgpr_read_b32 v132, a60
    v_mul_f32 v132, v132, v130
    v_accvgpr_write_b32 a60, v132
    v_accvgpr_read_b32 v132, a61
    v_mul_f32 v132, v132, v130
    v_accvgpr_write_b32 a61, v132
    v_accvgpr_read_b32 v132, a62
    v_mul_f32 v132, v132, v130
    v_accvgpr_write_b32 a62, v132
    v_accvgpr_read_b32 v132, a63
    v_mul_f32 v132, v132, v130
    v_accvgpr_write_b32 a63, v132
    v_accvgpr_read_b32 v132, a68
    v_mul_f32 v132, v132, v130
    v_accvgpr_write_b32 a68, v132
    v_accvgpr_read_b32 v132, a69
    v_mul_f32 v132, v132, v130
    v_accvgpr_write_b32 a69, v132
    v_accvgpr_read_b32 v132, a70
    v_mul_f32 v132, v132, v130
    v_accvgpr_write_b32 a70, v132
    v_accvgpr_read_b32 v132, a71
    v_mul_f32 v132, v132, v130
    v_accvgpr_write_b32 a71, v132
    v_sub_f32 v16, v16, v122
    v_sub_f32 v17, v17, v122
    v_sub_f32 v18, v18, v122
    v_sub_f32 v19, v19, v122
    v_sub_f32 v20, v20, v122
    v_sub_f32 v21, v21, v122
    v_sub_f32 v22, v22, v122
    v_sub_f32 v23, v23, v122
    v_sub_f32 v24, v24, v122
    v_sub_f32 v25, v25, v122
    v_sub_f32 v26, v26, v122
    v_sub_f32 v27, v27, v122
    v_sub_f32 v28, v28, v122
    v_sub_f32 v29, v29, v122
    v_sub_f32 v30, v30, v122
    v_sub_f32 v31, v31, v122
    v_exp_f32 v16, v16
    v_exp_f32 v17, v17
    v_exp_f32 v18, v18
    v_exp_f32 v19, v19
    v_exp_f32 v20, v20
    v_exp_f32 v21, v21
    v_exp_f32 v22, v22
    v_exp_f32 v23, v23
    v_exp_f32 v24, v24
    v_exp_f32 v25, v25
    v_exp_f32 v26, v26
    v_exp_f32 v27, v27
    v_exp_f32 v28, v28
    v_exp_f32 v29, v29
    v_exp_f32 v30, v30
    v_exp_f32 v31, v31
    s_nop 0
    v_cvt_pk_bf16_f32 v104, v16, v17
    v_cvt_pk_bf16_f32 v105, v18, v19
    v_cvt_pk_bf16_f32 v106, v20, v21
    v_cvt_pk_bf16_f32 v107, v22, v23
    v_cvt_pk_bf16_f32 v108, v24, v25
    v_cvt_pk_bf16_f32 v109, v26, v27
    v_cvt_pk_bf16_f32 v110, v28, v29
    v_cvt_pk_bf16_f32 v111, v30, v31
    s_nop 1
    v_mfma_f32_32x32x16_bf16 a[48:63], a[16:19], v[104:107], a[48:63]
    v_mfma_f32_32x32x16_bf16 a[48:63], a[20:23], v[108:111], a[48:63]
    v_smfmac_f32_16x16x64_bf16 a[68:71], v[112:115], v[104:111], v116
    s_add_u32 s34, s34, s35
    s_add_u32 s100, s100, 1
    s_cmp_lt_u32 s100, s99
    s_nop 15
    s_cbranch_scc1 L_fbl_b
    v_accvgpr_read_b32 v48, a48
    v_accvgpr_read_b32 v49, a49
    v_accvgpr_read_b32 v50, a50
    v_accvgpr_read_b32 v51, a51
    v_accvgpr_read_b32 v52, a52
    v_accvgpr_read_b32 v53, a53
    v_accvgpr_read_b32 v54, a54
    v_accvgpr_read_b32 v55, a55
    v_accvgpr_read_b32 v56, a56
    v_accvgpr_read_b32 v57, a57
    v_accvgpr_read_b32 v58, a58
    v_accvgpr_read_b32 v59, a59
    v_accvgpr_read_b32 v60, a60
    v_accvgpr_read_b32 v61, a61
    v_accvgpr_read_b32 v62, a62
    v_accvgpr_read_b32 v63, a63
    v_accvgpr_read_b32 v124, a68
    v_accvgpr_read_b32 v125, a69
    v_add_f32 v124, v124, v125
    s_mov_b32 s41, 1
    s_branch L_st_b
L_oproj:
    s_lshl_b32 s94, s68, 2
    s_add_u32 s94, s94, s20
    s_lshl_b32 s27, s94, 17
    s_add_u32 s27, s27, 20971520
    s_lshl_b32 s36, s20, 12
    v_add_u32 v99, s36, v142
    v_add_u32 v103, 0x10000, v99
    v_add_u32 v96, 147456, v142
    v_add_u32 v106, 131072, v99
    ds_read_b128 a[64:67], v106 offset:0
    ds_read_b128 a[0:3], v96 offset:0
    ds_read_b128 a[4:7], v96 offset:1024
    ds_read_b128 a[68:71], v106 offset:1024
    ds_read_b128 a[8:11], v96 offset:2048
    ds_read_b128 a[12:15], v96 offset:3072
    ds_read_b128 a[72:75], v106 offset:2048
    ds_read_b128 a[16:19], v96 offset:4096
    ds_read_b128 a[20:23], v96 offset:5120
    ds_read_b128 a[76:79], v106 offset:3072
    ds_read_b128 a[24:27], v96 offset:6144
    ds_read_b128 a[28:31], v96 offset:7168
    s_add_u32 s98, s98, 4096
    s_waitcnt lgkmcnt(9)
    v_mfma_f32_32x32x16_bf16 v[32:47], a[0:3], a[64:67], 0
    ds_read_b128 a[80:83], v103 offset:0
    ds_read_b128 a[32:35], v96 offset:8192
    v_mfma_f32_32x32x16_bf16 v[48:63], a[4:7], a[64:67], 0
    ds_read_b128 a[36:39], v96 offset:9216
    s_add_u32 s28, s27, 28672
    buffer_load_dwordx4 a[96:99], v142, s[12:15], s28 offen offset:0 sc1
    s_waitcnt lgkmcnt(9)
    v_mfma_f32_32x32x16_bf16 v[32:47], a[8:11], a[68:71], v[32:47]
    ds_read_b128 a[84:87], v103 offset:1024
    ds_read_b128 a[40:43], v96 offset:10240
    v_mfma_f32_32x32x16_bf16 v[48:63], a[12:15], a[68:71], v[48:63]
    ds_read_b128 a[44:47], v96 offset:11264
    buffer_load_dwordx4 a[100:103], v142, s[12:15], s28 offen offset:1024 sc1
    s_waitcnt lgkmcnt(9)
    v_mfma_f32_32x32x16_bf16 v[32:47], a[16:19], a[72:75], v[32:47]
    ds_read_b128 a[88:91], v103 offset:2048
    ds_read_b128 a[48:51], v96 offset:12288
    v_mfma_f32_32x32x16_bf16 v[48:63], a[20:23], a[72:75], v[48:63]
    ds_read_b128 a[52:55], v96 offset:13312
    buffer_load_dwordx4 a[104:107], v142, s[12:15], s28 offen offset:2048 sc1
    s_waitcnt lgkmcnt(9)
    v_mfma_f32_32x32x16_bf16 v[32:47], a[24:27], a[76:79], v[32:47]
    ds_read_b128 a[92:95], v103 offset:3072
    ds_read_b128 a[56:59], v96 offset:14336
    v_mfma_f32_32x32x16_bf16 v[48:63], a[28:31], a[76:79], v[48:63]
    ds_read_b128 a[60:63], v96 offset:15360
    buffer_load_dwordx4 a[108:111], v142, s[12:15], s28 offen offset:3072 sc1
    s_barrier
    s_waitcnt lgkmcnt(9)
    v_mfma_f32_32x32x16_bf16 v[32:47], a[32:35], a[80:83], v[32:47]
    ds_read_b128 a[64:67], v103 offset:16384
    ds_read_b128 a[0:3], v142 offset:32768
    v_mfma_f32_32x32x16_bf16 v[48:63], a[36:39], a[80:83], v[48:63]
    ds_read_b128 a[4:7], v142 offset:33792
    s_add_u32 s28, s27, 32768
    buffer_load_dwordx4 v[108:111], v142, s[12:15], s28 offen offset:0 sc1
    s_waitcnt lgkmcnt(9)
    v_mfma_f32_32x32x16_bf16 v[32:47], a[40:43], a[84:87], v[32:47]
    ds_read_b128 a[68:71], v103 offset:17408
    ds_read_b128 a[8:11], v142 offset:34816
    v_mfma_f32_32x32x16_bf16 v[48:63], a[44:47], a[84:87], v[48:63]
    ds_read_b128 a[12:15], v142 offset:35840
    buffer_load_dwordx4 v[112:115], v142, s[12:15], s28 offen offset:1024 sc1
    s_waitcnt lgkmcnt(9)
    v_mfma_f32_32x32x16_bf16 v[32:47], a[48:51], a[88:91], v[32:47]
    ds_read_b128 a[72:75], v103 offset:18432
    ds_read_b128 a[16:19], v142 offset:36864
    v_mfma_f32_32x32x16_bf16 v[48:63], a[52:55], a[88:91], v[48:63]
    ds_read_b128 a[20:23], v142 offset:37888
    buffer_load_dwordx4 v[116:119], v142, s[12:15], s28 offen offset:2048 sc1
    s_waitcnt lgkmcnt(9)
    v_mfma_f32_32x32x16_bf16 v[32:47], a[56:59], a[92:95], v[32:47]
    ds_read_b128 a[76:79], v103 offset:19456
    ds_read_b128 a[24:27], v142 offset:38912
    v_mfma_f32_32x32x16_bf16 v[48:63], a[60:63], a[92:95], v[48:63]
    ds_read_b128 a[28:31], v142 offset:39936
    buffer_load_dwordx4 v[120:123], v142, s[12:15], s28 offen offset:3072 sc1
    s_waitcnt lgkmcnt(9)
    v_mfma_f32_32x32x16_bf16 v[32:47], a[0:3], a[64:67], v[32:47]
    ds_read_b128 a[80:83], v103 offset:32768
    ds_read_b128 a[32:35], v142 offset:40960
    v_mfma_f32_32x32x16_bf16 v[48:63], a[4:7], a[64:67], v[48:63]
    ds_read_b128 a[36:39], v142 offset:41984
    s_waitcnt lgkmcnt(9)
    v_mfma_f32_32x32x16_bf16 v[32:47], a[8:11], a[68:71], v[32:47]
    ds_read_b128 a[84:87], v103 offset:33792
    ds_read_b128 a[40:43], v142 offset:43008
    v_mfma_f32_32x32x16_bf16 v[48:63], a[12:15], a[68:71], v[48:63]
    ds_read_b128 a[44:47], v142 offset:44032
    s_waitcnt lgkmcnt(9)
    v_mfma_f32_32x32x16_bf16 v[32:47], a[16:19], a[72:75], v[32:47]
    ds_read_b128 a[88:91], v103 offset:34816
    ds_read_b128 a[48:51], v142 offset:45056
    s_waitcnt vmcnt(8)
    v_mov_b32 v139, s32
    v_min_u32 v140, 1, v143
    v_lshlrev_b32 v140, 30, v140
    buffer_store_dword v139, v140, s[12:15], s98 offen sc1
    v_mfma_f32_32x32x16_bf16 v[48:63], a[20:23], a[72:75], v[48:63]
    ds_read_b128 a[52:55], v142 offset:46080
    s_add_u32 s28, s27, 36864
    buffer_load_dwordx4 v[0:3], v142, s[12:15], s28 offen offset:0 sc1
    buffer_load_dwordx4 v[4:7], v142, s[12:15], s28 offen offset:1024 sc1
    s_waitcnt lgkmcnt(9)
    v_mfma_f32_32x32x16_bf16 v[32:47], a[24:27], a[76:79], v[32:47]
    ds_read_b128 a[92:95], v103 offset:35840
    ds_read_b128 a[56:59], v142 offset:47104
    buffer_load_dwordx4 v[8:11], v142, s[12:15], s28 offen offset:2048 sc1
    buffer_load_dwordx4 v[12:15], v142, s[12:15], s28 offen offset:3072 sc1
    v_mfma_f32_32x32x16_bf16 v[48:63], a[28:31], a[76:79], v[48:63]
    ds_read_b128 a[60:63], v142 offset:48128
    s_barrier
    s_waitcnt lgkmcnt(9)
    v_mfma_f32_32x32x16_bf16 v[32:47], a[32:35], a[80:83], v[32:47]
    ds_read_b128 a[64:67], v103 offset:49152
    ds_read_b128 a[0:3], v142 offset:49152
    v_mfma_f32_32x32x16_bf16 v[48:63], a[36:39], a[80:83], v[48:63]
    ds_read_b128 a[4:7], v142 offset:50176
    s_waitcnt lgkmcnt(9)
    v_mfma_f32_32x32x16_bf16 v[32:47], a[40:43], a[84:87], v[32:47]
    ds_read_b128 a[68:71], v103 offset:50176
    ds_read_b128 a[8:11], v142 offset:51200
    v_mfma_f32_32x32x16_bf16 v[48:63], a[44:47], a[84:87], v[48:63]
    ds_read_b128 a[12:15], v142 offset:52224
    s_waitcnt lgkmcnt(9)
    v_mfma_f32_32x32x16_bf16 v[32:47], a[48:51], a[88:91], v[32:47]
    ds_read_b128 a[72:75], v103 offset:51200
    ds_read_b128 a[16:19], v142 offset:53248
    s_add_u32 s28, s27, 40960
    buffer_load_dwordx4 v[16:19], v142, s[12:15], s28 offen offset:0 sc1
    v_mfma_f32_32x32x16_bf16 v[48:63], a[52:55], a[88:91], v[48:63]
    ds_read_b128 a[20:23], v142 offset:54272
    buffer_load_dwordx4 v[20:23], v142, s[12:15], s28 offen offset:1024 sc1
    s_waitcnt lgkmcnt(9)
    v_mfma_f32_32x32x16_bf16 v[32:47], a[56:59], a[92:95], v[32:47]
    ds_read_b128 a[76:79], v103 offset:52224
    ds_read_b128 a[24:27], v142 offset:55296
    buffer_load_dwordx4 v[24:27], v142, s[12:15], s28 offen offset:2048 sc1
    v_mfma_f32_32x32x16_bf16 v[48:63], a[60:63], a[92:95], v[48:63]
    ds_read_b128 a[28:31], v142 offset:56320
    buffer_load_dwordx4 v[28:31], v142, s[12:15], s28 offen offset:3072 sc1
    s_waitcnt lgkmcnt(9)
    v_mfma_f32_32x32x16_bf16 v[32:47], a[0:3], a[64:67], v[32:47]
    ds_read_b128 a[80:83], v99 offset:0
    ds_read_b128 a[32:35], v142 offset:57344
    v_and_b32 v104, 31, v143
    v_lshlrev_b32 v102, 3, v104
    v_mfma_f32_32x32x16_bf16 v[48:63], a[4:7], a[64:67], v[48:63]
    ds_read_b128 a[36:39], v142 offset:58368
    v_lshlrev_b32 v104, 11, v104
    v_lshrrev_b32 v105, 5, v143
    s_waitcnt lgkmcnt(9)
    v_mfma_f32_32x32x16_bf16 v[32:47], a[8:11], a[68:71], v[32:47]
    ds_read_b128 a[84:87], v99 offset:1024
    ds_read_b128 a[40:43], v142 offset:59392
    v_lshl_add_u32 v98, v105, 5, v104
    s_lshl_b32 s37, s94, 8
    v_mfma_f32_32x32x16_bf16 v[48:63], a[12:15], a[68:71], v[48:63]
    ds_read_b128 a[44:47], v142 offset:60416
    s_add_u32 s37, s37, 33554432
    s_mov_b32 s16, s62
    s_waitcnt lgkmcnt(9)
    v_mfma_f32_32x32x16_bf16 v[32:47], a[16:19], a[72:75], v[32:47]
    ds_read_b128 a[88:91], v99 offset:2048
    ds_read_b128 a[48:51], v142 offset:61440
    s_mov_b32 s17, s63
    s_mov_b32 s18, 0x400000
    v_mfma_f32_32x32x16_bf16 v[48:63], a[20:23], a[72:75], v[48:63]
    ds_read_b128 a[52:55], v142 offset:62464
    s_lshl_b32 s36, s94, 16
    s_lshl_b32 s38, s69, 7
    s_waitcnt lgkmcnt(9)
    v_mfma_f32_32x32x16_bf16 v[32:47], a[24:27], a[76:79], v[32:47]
    ds_read_b128 a[92:95], v99 offset:3072
    ds_read_b128 a[56:59], v142 offset:63488
    s_add_u32 s36, s36, s38
    v_mfma_f32_32x32x16_bf16 v[48:63], a[28:31], a[76:79], v[48:63]
    ds_read_b128 a[60:63], v142 offset:64512
    s_barrier
    s_waitcnt lgkmcnt(9)
    v_mfma_f32_32x32x16_bf16 v[32:47], a[32:35], a[80:83], v[32:47]
    ds_read_b128 a[64:67], v99 offset:16384
    ds_read_b128 a[0:3], v96 offset:0
    v_mfma_f32_32x32x16_bf16 v[48:63], a[36:39], a[80:83], v[48:63]
    ds_read_b128 a[4:7], v96 offset:1024
    s_add_u32 s28, s27, 45056
    buffer_load_dwordx4 a[80:83], v142, s[12:15], s28 offen offset:0 sc1
    s_waitcnt lgkmcnt(9)
    v_mfma_f32_32x32x16_bf16 v[32:47], a[40:43], a[84:87], v[32:47]
    ds_read_b128 a[68:71], v99 offset:17408
    ds_read_b128 a[8:11], v96 offset:2048
    v_mfma_f32_32x32x16_bf16 v[48:63], a[44:47], a[84:87], v[48:63]
    ds_read_b128 a[12:15], v96 offset:3072
    buffer_load_dwordx4 a[84:87], v142, s[12:15], s28 offen offset:1024 sc1
    s_waitcnt lgkmcnt(9)
    v_mfma_f32_32x32x16_bf16 v[32:47], a[48:51], a[88:91], v[32:47]
    ds_read_b128 a[72:75], v99 offset:18432
    ds_read_b128 a[16:19], v96 offset:4096
    v_mfma_f32_32x32x16_bf16 v[48:63], a[52:55], a[88:91], v[48:63]
    ds_read_b128 a[20:23], v96 offset:5120
    buffer_load_dwordx4 a[88:91], v142, s[12:15], s28 offen offset:2048 sc1
    s_waitcnt lgkmcnt(9)
    v_mfma_f32_32x32x16_bf16 v[32:47], a[56:59], a[92:95], v[32:47]
    ds_read_b128 a[76:79], v99 offset:19456
    ds_read_b128 a[24:27], v96 offset:6144
    v_mfma_f32_32x32x16_bf16 v[48:63], a[60:63], a[92:95], v[48:63]
    ds_read_b128 a[28:31], v96 offset:7168
    buffer_load_dwordx4 a[92:95], v142, s[12:15], s28 offen offset:3072 sc1
    s_waitcnt lgkmcnt(9)
    v_mfma_f32_32x32x16_bf16 v[32:47], a[0:3], a[64:67], v[32:47]
    ds_read_b128 a[32:35], v96 offset:8192
    v_mfma_f32_32x32x16_bf16 v[48:63], a[4:7], a[64:67], v[48:63]
    ds_read_b128 a[36:39], v96 offset:9216
    s_add_u32 s28, s27, 49152
    buffer_load_dwordx4 a[64:67], v142, s[12:15], s28 offen offset:0 sc1
    s_waitcnt lgkmcnt(8)
    v_mfma_f32_32x32x16_bf16 v[32:47], a[8:11], a[68:71], v[32:47]
    ds_read_b128 a[40:43], v96 offset:10240
    v_mfma_f32_32x32x16_bf16 v[48:63], a[12:15], a[68:71], v[48:63]
    ds_read_b128 a[44:47], v96 offset:11264
    buffer_load_dwordx4 a[68:71], v142, s[12:15], s28 offen offset:1024 sc1
    s_waitcnt lgkmcnt(7)
    v_mfma_f32_32x32x16_bf16 v[32:47], a[16:19], a[72:75], v[32:47]
    ds_read_b128 a[48:51], v96 offset:12288
    v_mfma_f32_32x32x16_bf16 v[48:63], a[20:23], a[72:75], v[48:63]
    ds_read_b128 a[52:55], v96 offset:13312
    buffer_load_dwordx4 a[72:75], v142, s[12:15], s28 offen offset:2048 sc1
    s_waitcnt lgkmcnt(6)
    v_mfma_f32_32x32x16_bf16 v[32:47], a[24:27], a[76:79], v[32:47]
    ds_read_b128 a[56:59], v96 offset:14336
    v_mfma_f32_32x32x16_bf16 v[48:63], a[28:31], a[76:79], v[48:63]
    ds_read_b128 a[60:63], v96 offset:15360
    buffer_load_dwordx4 a[76:79], v142, s[12:15], s28 offen offset:3072 sc1
    s_barrier
    s_waitcnt vmcnt(21) lgkmcnt(6)
    v_mfma_f32_32x32x16_bf16 v[32:47], a[32:35], a[96:99], v[32:47]
    ds_read_b128 a[0:3], v142 offset:32768
    v_mfma_f32_32x32x16_bf16 v[48:63], a[36:39], a[96:99], v[48:63]
    ds_read_b128 a[4:7], v142 offset:33792
    s_add_u32 s28, s27, 53248
    buffer_load_dwordx4 a[96:99], v142, s[12:15], s28 offen offset:0 sc1
    s_waitcnt lgkmcnt(6)
    v_mfma_f32_32x32x16_bf16 v[32:47], a[40:43], a[100:103], v[32:47]
    ds_read_b128 a[8:11], v142 offset:34816
    v_mfma_f32_32x32x16_bf16 v[48:63], a[44:47], a[100:103], v[48:63]
    ds_read_b128 a[12:15], v142 offset:35840
    buffer_load_dwordx4 a[100:103], v142, s[12:15], s28 offen offset:1024 sc1
    s_waitcnt lgkmcnt(6)
    v_mfma_f32_32x32x16_bf16 v[32:47], a[48:51], a[104:107], v[32:47]
    ds_read_b128 a[16:19], v142 offset:36864
    v_mfma_f32_32x32x16_bf16 v[48:63], a[52:55], a[104:107], v[48:63]
    ds_read_b128 a[20:23], v142 offset:37888
    buffer_load_dwordx4 a[104:107], v142, s[12:15], s28 offen offset:2048 sc1
    s_waitcnt lgkmcnt(6)
    v_mfma_f32_32x32x16_bf16 v[32:47], a[56:59], a[108:111], v[32:47]
    ds_read_b128 a[24:27], v142 offset:38912
    v_mfma_f32_32x32x16_bf16 v[48:63], a[60:63], a[108:111], v[48:63]
    ds_read_b128 a[28:31], v142 offset:39936
    buffer_load_dwordx4 a[108:111], v142, s[12:15], s28 offen offset:3072 sc1
    s_waitcnt vmcnt(21) lgkmcnt(6)
    v_mfma_f32_32x32x16_bf16 v[32:47], a[0:3], v[108:111], v[32:47]
    ds_read_b128 a[32:35], v142 offset:40960
    v_mfma_f32_32x32x16_bf16 v[48:63], a[4:7], v[108:111], v[48:63]
    ds_read_b128 a[36:39], v142 offset:41984
    s_add_u32 s28, s27, 57344
    buffer_load_dwordx4 v[108:111], v142, s[12:15], s28 offen offset:0 sc1
    s_waitcnt lgkmcnt(6)
    v_mfma_f32_32x32x16_bf16 v[32:47], a[8:11], v[112:115], v[32:47]
    ds_read_b128 a[40:43], v142 offset:43008
    v_mfma_f32_32x32x16_bf16 v[48:63], a[12:15], v[112:115], v[48:63]
    ds_read_b128 a[44:47], v142 offset:44032
    buffer_load_dwordx4 v[112:115], v142, s[12:15], s28 offen offset:1024 sc1
    s_waitcnt lgkmcnt(6)
    v_mfma_f32_32x32x16_bf16 v[32:47], a[16:19], v[116:119], v[32:47]
    ds_read_b128 a[48:51], v142 offset:45056
    v_mfma_f32_32x32x16_bf16 v[48:63], a[20:23], v[116:119], v[48:63]
    ds_read_b128 a[52:55], v142 offset:46080
    buffer_load_dwordx4 v[116:119], v142, s[12:15], s28 offen offset:2048 sc1
    s_waitcnt lgkmcnt(6)
    v_mfma_f32_32x32x16_bf16 v[32:47], a[24:27], v[120:123], v[32:47]
    ds_read_b128 a[56:59], v142 offset:47104
    v_mfma_f32_32x32x16_bf16 v[48:63], a[28:31], v[120:123], v[48:63]
    ds_read_b128 a[60:63], v142 offset:48128
    buffer_load_dwordx4 v[120:123], v142, s[12:15], s28 offen offset:3072 sc1
    s_barrier
    s_waitcnt vmcnt(20) lgkmcnt(6)
    v_mfma_f32_32x32x16_bf16 v[32:47], a[32:35], v[0:3], v[32:47]
    ds_read_b128 a[0:3], v142 offset:49152
    v_mfma_f32_32x32x16_bf16 v[48:63], a[36:39], v[0:3], v[48:63]
    ds_read_b128 a[4:7], v142 offset:50176
    s_add_u32 s28, s27, 61440
    buffer_load_dwordx4 v[0:3], v142, s[12:15], s28 offen offset:0 sc1
    s_waitcnt lgkmcnt(6)
    v_mfma_f32_32x32x16_bf16 v[32:47], a[40:43], v[4:7], v[32:47]
    ds_read_b128 a[8:11], v142 offset:51200
    v_mfma_f32_32x32x16_bf16 v[48:63], a[44:47], v[4:7], v[48:63]
    ds_read_b128 a[12:15], v142 offset:52224
    buffer_load_dwordx4 v[4:7], v142, s[12:15], s28 offen offset:1024 sc1
    s_waitcnt lgkmcnt(6)
    v_mfma_f32_32x32x16_bf16 v[32:47], a[48:51], v[8:11], v[32:47]
    ds_read_b128 a[16:19], v142 offset:53248
    v_mfma_f32_32x32x16_bf16 v[48:63], a[52:55], v[8:11], v[48:63]
    ds_read_b128 a[20:23], v142 offset:54272
    buffer_load_dwordx4 v[8:11], v142, s[12:15], s28 offen offset:2048 sc1
    s_waitcnt lgkmcnt(6)
    v_mfma_f32_32x32x16_bf16 v[32:47], a[56:59], v[12:15], v[32:47]
    ds_read_b128 a[24:27], v142 offset:55296
    v_mfma_f32_32x32x16_bf16 v[48:63], a[60:63], v[12:15], v[48:63]
    ds_read_b128 a[28:31], v142 offset:56320
    buffer_load_dwordx4 v[12:15], v142, s[12:15], s28 offen offset:3072 sc1
    s_waitcnt vmcnt(20) lgkmcnt(6)
    v_mfma_f32_32x32x16_bf16 v[32:47], a[0:3], v[16:19], v[32:47]
    ds_read_b128 a[32:35], v142 offset:57344
    v_mfma_f32_32x32x16_bf16 v[48:63], a[4:7], v[16:19], v[48:63]
    ds_read_b128 a[36:39], v142 offset:58368
    s_waitcnt lgkmcnt(6)
    v_mfma_f32_32x32x16_bf16 v[32:47], a[8:11], v[20:23], v[32:47]
    ds_read_b128 a[40:43], v142 offset:59392
    v_mfma_f32_32x32x16_bf16 v[48:63], a[12:15], v[20:23], v[48:63]
    ds_read_b128 a[44:47], v142 offset:60416
    s_waitcnt lgkmcnt(6)
    v_mfma_f32_32x32x16_bf16 v[32:47], a[16:19], v[24:27], v[32:47]
    ds_read_b128 a[48:51], v142 offset:61440
    v_mfma_f32_32x32x16_bf16 v[48:63], a[20:23], v[24:27], v[48:63]
    ds_read_b128 a[52:55], v142 offset:62464
    s_waitcnt lgkmcnt(6)
    v_mfma_f32_32x32x16_bf16 v[32:47], a[24:27], v[28:31], v[32:47]
    ds_read_b128 a[56:59], v142 offset:63488
    v_mfma_f32_32x32x16_bf16 v[48:63], a[28:31], v[28:31], v[48:63]
    ds_read_b128 a[60:63], v142 offset:64512
    s_barrier
    s_waitcnt vmcnt(16) lgkmcnt(6)
    v_mfma_f32_32x32x16_bf16 v[32:47], a[32:35], a[80:83], v[32:47]
    ds_read_b128 a[0:3], v96 offset:0
    s_add_u32 s28, s27, 65536
    buffer_load_dwordx4 v[16:19], v142, s[12:15], s28 offen offset:0 sc1
    buffer_load_dwordx4 v[20:23], v142, s[12:15], s28 offen offset:1024 sc1
    buffer_load_dwordx4 v[24:27], v142, s[12:15], s28 offen offset:2048 sc1
    buffer_load_dwordx4 v[28:31], v142, s[12:15], s28 offen offset:3072 sc1
    v_mfma_f32_32x32x16_bf16 v[48:63], a[36:39], a[80:83], v[48:63]
    ds_read_b128 a[4:7], v96 offset:1024
    s_add_u32 s28, s27, 69632
    buffer_load_dwordx4 a[80:83], v142, s[12:15], s28 offen offset:0 sc1
    s_waitcnt lgkmcnt(6)
    v_mfma_f32_32x32x16_bf16 v[32:47], a[40:43], a[84:87], v[32:47]
    ds_read_b128 a[8:11], v96 offset:2048
    v_mfma_f32_32x32x16_bf16 v[48:63], a[44:47], a[84:87], v[48:63]
    ds_read_b128 a[12:15], v96 offset:3072
    buffer_load_dwordx4 a[84:87], v142, s[12:15], s28 offen offset:1024 sc1
    s_waitcnt lgkmcnt(6)
    v_mfma_f32_32x32x16_bf16 v[32:47], a[48:51], a[88:91], v[32:47]
    ds_read_b128 a[16:19], v96 offset:4096
    v_mfma_f32_32x32x16_bf16 v[48:63], a[52:55], a[88:91], v[48:63]
    ds_read_b128 a[20:23], v96 offset:5120
    buffer_load_dwordx4 a[88:91], v142, s[12:15], s28 offen offset:2048 sc1
    s_waitcnt lgkmcnt(6)
    v_mfma_f32_32x32x16_bf16 v[32:47], a[56:59], a[92:95], v[32:47]
    ds_read_b128 a[24:27], v96 offset:6144
    v_mfma_f32_32x32x16_bf16 v[48:63], a[60:63], a[92:95], v[48:63]
    ds_read_b128 a[28:31], v96 offset:7168
    buffer_load_dwordx4 a[92:95], v142, s[12:15], s28 offen offset:3072 sc1
    s_waitcnt vmcnt(20) lgkmcnt(6)
    v_mfma_f32_32x32x16_bf16 v[32:47], a[0:3], a[64:67], v[32:47]
    ds_read_b128 a[32:35], v96 offset:8192
    v_mfma_f32_32x32x16_bf16 v[48:63], a[4:7], a[64:67], v[48:63]
    ds_read_b128 a[36:39], v96 offset:9216
    s_add_u32 s28, s27, 73728
    buffer_load_dwordx4 a[64:67], v142, s[12:15], s28 offen offset:0 sc1
    s_waitcnt lgkmcnt(6)
    v_mfma_f32_32x32x16_bf16 v[32:47], a[8:11], a[68:71], v[32:47]
    ds_read_b128 a[40:43], v96 offset:10240
    v_mfma_f32_32x32x16_bf16 v[48:63], a[12:15], a[68:71], v[48:63]
    ds_read_b128 a[44:47], v96 offset:11264
    buffer_load_dwordx4 a[68:71], v142, s[12:15], s28 offen offset:1024 sc1
    s_waitcnt lgkmcnt(6)
    v_mfma_f32_32x32x16_bf16 v[32:47], a[16:19], a[72:75], v[32:47]
    ds_read_b128 a[48:51], v96 offset:12288
    v_mfma_f32_32x32x16_bf16 v[48:63], a[20:23], a[72:75], v[48:63]
    ds_read_b128 a[52:55], v96 offset:13312
    buffer_load_dwordx4 a[72:75], v142, s[12:15], s28 offen offset:2048 sc1
    s_waitcnt lgkmcnt(6)
    v_mfma_f32_32x32x16_bf16 v[32:47], a[24:27], a[76:79], v[32:47]
    ds_read_b128 a[56:59], v96 offset:14336
    v_mfma_f32_32x32x16_bf16 v[48:63], a[28:31], a[76:79], v[48:63]
    ds_read_b128 a[60:63], v96 offset:15360
    buffer_load_dwordx4 a[76:79], v142, s[12:15], s28 offen offset:3072 sc1
    s_barrier
    s_waitcnt vmcnt(20) lgkmcnt(6)
    v_mfma_f32_32x32x16_bf16 v[32:47], a[32:35], a[96:99], v[32:47]
    ds_read_b128 a[0:3], v142 offset:32768
    v_mfma_f32_32x32x16_bf16 v[48:63], a[36:39], a[96:99], v[48:63]
    ds_read_b128 a[4:7], v142 offset:33792
    s_add_u32 s28, s27, 77824
    buffer_load_dwordx4 a[96:99], v142, s[12:15], s28 offen offset:0 sc1
    s_waitcnt lgkmcnt(6)
    v_mfma_f32_32x32x16_bf16 v[32:47], a[40:43], a[100:103], v[32:47]
    ds_read_b128 a[8:11], v142 offset:34816
    v_mfma_f32_32x32x16_bf16 v[48:63], a[44:47], a[100:103], v[48:63]
    ds_read_b128 a[12:15], v142 offset:35840
    buffer_load_dwordx4 a[100:103], v142, s[12:15], s28 offen offset:1024 sc1
    s_waitcnt lgkmcnt(6)
    v_mfma_f32_32x32x16_bf16 v[32:47], a[48:51], a[104:107], v[32:47]
    ds_read_b128 a[16:19], v142 offset:36864
    buffer_load_dwordx2 v[100:101], v102, s[12:15], s37 offen sc1
    v_mfma_f32_32x32x16_bf16 v[48:63], a[52:55], a[104:107], v[48:63]
    ds_read_b128 a[20:23], v142 offset:37888
    buffer_load_dwordx4 a[104:107], v142, s[12:15], s28 offen offset:2048 sc1
    s_waitcnt lgkmcnt(6)
    v_mfma_f32_32x32x16_bf16 v[32:47], a[56:59], a[108:111], v[32:47]
    ds_read_b128 a[24:27], v142 offset:38912
    v_mfma_f32_32x32x16_bf16 v[48:63], a[60:63], a[108:111], v[48:63]
    ds_read_b128 a[28:31], v142 offset:39936
    buffer_load_dwordx4 a[108:111], v142, s[12:15], s28 offen offset:3072 sc1
    s_waitcnt vmcnt(21) lgkmcnt(6)
    v_mfma_f32_32x32x16_bf16 v[32:47], a[0:3], v[108:111], v[32:47]
    ds_read_b128 a[32:35], v142 offset:40960
    v_mfma_f32_32x32x16_bf16 v[48:63], a[4:7], v[108:111], v[48:63]
    ds_read_b128 a[36:39], v142 offset:41984
    s_add_u32 s28, s27, 81920
    buffer_load_dwordx4 v[108:111], v142, s[12:15], s28 offen offset:0 sc1
    s_waitcnt lgkmcnt(6)
    v_mfma_f32_32x32x16_bf16 v[32:47], a[8:11], v[112:115], v[32:47]
    ds_read_b128 a[40:43], v142 offset:43008
    v_mfma_f32_32x32x16_bf16 v[48:63], a[12:15], v[112:115], v[48:63]
    ds_read_b128 a[44:47], v142 offset:44032
    buffer_load_dwordx4 v[112:115], v142, s[12:15], s28 offen offset:1024 sc1
    s_waitcnt lgkmcnt(6)
    v_mfma_f32_32x32x16_bf16 v[32:47], a[16:19], v[116:119], v[32:47]
    ds_read_b128 a[48:51], v142 offset:45056
    v_mfma_f32_32x32x16_bf16 v[48:63], a[20:23], v[116:119], v[48:63]
    ds_read_b128 a[52:55], v142 offset:46080
    buffer_load_dwordx4 v[116:119], v142, s[12:15], s28 offen offset:2048 sc1
    s_waitcnt lgkmcnt(6)
    v_mfma_f32_32x32x16_bf16 v[32:47], a[24:27], v[120:123], v[32:47]
    ds_read_b128 a[56:59], v142 offset:47104
    v_mfma_f32_32x32x16_bf16 v[48:63], a[28:31], v[120:123], v[48:63]
    ds_read_b128 a[60:63], v142 offset:48128
    buffer_load_dwordx4 v[120:123], v142, s[12:15], s28 offen offset:3072 sc1
    s_barrier
    s_waitcnt vmcnt(21) lgkmcnt(6)
    v_mfma_f32_32x32x16_bf16 v[32:47], a[32:35], v[0:3], v[32:47]
    ds_read_b128 a[0:3], v142 offset:49152
    v_mfma_f32_32x32x16_bf16 v[48:63], a[36:39], v[0:3], v[48:63]
    ds_read_b128 a[4:7], v142 offset:50176
    s_add_u32 s28, s27, 86016
    buffer_load_dwordx4 v[0:3], v142, s[12:15], s28 offen offset:0 sc1
    s_waitcnt lgkmcnt(6)
    v_mfma_f32_32x32x16_bf16 v[32:47], a[40:43], v[4:7], v[32:47]
    ds_read_b128 a[8:11], v142 offset:51200
    v_mfma_f32_32x32x16_bf16 v[48:63], a[44:47], v[4:7], v[48:63]
    ds_read_b128 a[12:15], v142 offset:52224
    buffer_load_dwordx4 v[4:7], v142, s[12:15], s28 offen offset:1024 sc1
    s_waitcnt lgkmcnt(6)
    v_mfma_f32_32x32x16_bf16 v[32:47], a[48:51], v[8:11], v[32:47]
    ds_read_b128 a[16:19], v142 offset:53248
    v_mfma_f32_32x32x16_bf16 v[48:63], a[52:55], v[8:11], v[48:63]
    ds_read_b128 a[20:23], v142 offset:54272
    buffer_load_dwordx4 v[8:11], v142, s[12:15], s28 offen offset:2048 sc1
    s_waitcnt lgkmcnt(6)
    v_mfma_f32_32x32x16_bf16 v[32:47], a[56:59], v[12:15], v[32:47]
    ds_read_b128 a[24:27], v142 offset:55296
    v_mfma_f32_32x32x16_bf16 v[48:63], a[60:63], v[12:15], v[48:63]
    ds_read_b128 a[28:31], v142 offset:56320
    buffer_load_dwordx4 v[12:15], v142, s[12:15], s28 offen offset:3072 sc1
    s_waitcnt vmcnt(21) lgkmcnt(6)
    v_mfma_f32_32x32x16_bf16 v[64:79], a[0:3], v[16:19], 0
    ds_read_b128 a[32:35], v142 offset:57344
    v_mfma_f32_32x32x16_bf16 v[80:95], a[4:7], v[16:19], 0
    ds_read_b128 a[36:39], v142 offset:58368
    s_add_u32 s28, s27, 90112
    buffer_load_dwordx4 v[16:19], v142, s[12:15], s28 offen offset:0 sc1
    s_waitcnt lgkmcnt(6)
    v_mfma_f32_32x32x16_bf16 v[64:79], a[8:11], v[20:23], v[64:79]
    ds_read_b128 a[40:43], v142 offset:59392
    v_mfma_f32_32x32x16_bf16 v[80:95], a[12:15], v[20:23], v[80:95]
    ds_read_b128 a[44:47], v142 offset:60416
    buffer_load_dwordx4 v[20:23], v142, s[12:15], s28 offen offset:1024 sc1
    s_waitcnt lgkmcnt(6)
    v_mfma_f32_32x32x16_bf16 v[64:79], a[16:19], v[24:27], v[64:79]
    ds_read_b128 a[48:51], v142 offset:61440
    v_mfma_f32_32x32x16_bf16 v[80:95], a[20:23], v[24:27], v[80:95]
    ds_read_b128 a[52:55], v142 offset:62464
    buffer_load_dwordx4 v[24:27], v142, s[12:15], s28 offen offset:2048 sc1
    s_waitcnt lgkmcnt(6)
    v_mfma_f32_32x32x16_bf16 v[64:79], a[24:27], v[28:31], v[64:79]
    ds_read_b128 a[56:59], v142 offset:63488
    v_mfma_f32_32x32x16_bf16 v[80:95], a[28:31], v[28:31], v[80:95]
    ds_read_b128 a[60:63], v142 offset:64512
    buffer_load_dwordx4 v[28:31], v142, s[12:15], s28 offen offset:3072 sc1
    s_barrier
    s_waitcnt vmcnt(21) lgkmcnt(6)
    v_mfma_f32_32x32x16_bf16 v[64:79], a[32:35], a[80:83], v[64:79]
    ds_read_b128 a[0:3], v96 offset:0
    v_mfma_f32_32x32x16_bf16 v[80:95], a[36:39], a[80:83], v[80:95]
    ds_read_b128 a[4:7], v96 offset:1024
    s_add_u32 s28, s27, 94208
    buffer_load_dwordx4 a[80:83], v142, s[12:15], s28 offen offset:0 sc1
    s_waitcnt lgkmcnt(6)
    v_mfma_f32_32x32x16_bf16 v[64:79], a[40:43], a[84:87], v[64:79]
    ds_read_b128 a[8:11], v96 offset:2048
    v_mfma_f32_32x32x16_bf16 v[80:95], a[44:47], a[84:87], v[80:95]
    ds_read_b128 a[12:15], v96 offset:3072
    buffer_load_dwordx4 a[84:87], v142, s[12:15], s28 offen offset:1024 sc1
    s_waitcnt lgkmcnt(6)
    v_mfma_f32_32x32x16_bf16 v[64:79], a[48:51], a[88:91], v[64:79]
    ds_read_b128 a[16:19], v96 offset:4096
    v_mfma_f32_32x32x16_bf16 v[80:95], a[52:55], a[88:91], v[80:95]
    ds_read_b128 a[20:23], v96 offset:5120
    buffer_load_dwordx4 a[88:91], v142, s[12:15], s28 offen offset:2048 sc1
    s_waitcnt lgkmcnt(6)
    v_mfma_f32_32x32x16_bf16 v[64:79], a[56:59], a[92:95], v[64:79]
    ds_read_b128 a[24:27], v96 offset:6144
    v_mfma_f32_32x32x16_bf16 v[80:95], a[60:63], a[92:95], v[80:95]
    ds_read_b128 a[28:31], v96 offset:7168
    buffer_load_dwordx4 a[92:95], v142, s[12:15], s28 offen offset:3072 sc1
    s_waitcnt vmcnt(21) lgkmcnt(6)
    v_mfma_f32_32x32x16_bf16 v[64:79], a[0:3], a[64:67], v[64:79]
    ds_read_b128 a[32:35], v96 offset:8192
    v_mfma_f32_32x32x16_bf16 v[80:95], a[4:7], a[64:67], v[80:95]
    ds_read_b128 a[36:39], v96 offset:9216
    s_add_u32 s28, s27, 98304
    buffer_load_dwordx4 a[64:67], v142, s[12:15], s28 offen offset:0 sc1
    s_waitcnt lgkmcnt(6)
    v_mfma_f32_32x32x16_bf16 v[64:79], a[8:11], a[68:71], v[64:79]
    ds_read_b128 a[40:43], v96 offset:10240
    v_mfma_f32_32x32x16_bf16 v[80:95], a[12:15], a[68:71], v[80:95]
    ds_read_b128 a[44:47], v96 offset:11264
    buffer_load_dwordx4 a[68:71], v142, s[12:15], s28 offen offset:1024 sc1
    s_waitcnt lgkmcnt(6)
    v_mfma_f32_32x32x16_bf16 v[64:79], a[16:19], a[72:75], v[64:79]
    ds_read_b128 a[48:51], v96 offset:12288
    v_mfma_f32_32x32x16_bf16 v[80:95], a[20:23], a[72:75], v[80:95]
    ds_read_b128 a[52:55], v96 offset:13312
    buffer_load_dwordx4 a[72:75], v142, s[12:15], s28 offen offset:2048 sc1
    s_waitcnt lgkmcnt(6)
    v_mfma_f32_32x32x16_bf16 v[64:79], a[24:27], a[76:79], v[64:79]
    ds_read_b128 a[56:59], v96 offset:14336
    v_mfma_f32_32x32x16_bf16 v[80:95], a[28:31], a[76:79], v[80:95]
    ds_read_b128 a[60:63], v96 offset:15360
    buffer_load_dwordx4 a[76:79], v142, s[12:15], s28 offen offset:3072 sc1
    s_barrier
    s_waitcnt vmcnt(20) lgkmcnt(6)
    v_mfma_f32_32x32x16_bf16 v[64:79], a[32:35], a[96:99], v[64:79]
    ds_read_b128 a[0:3], v142 offset:32768
    v_mfma_f32_32x32x16_bf16 v[80:95], a[36:39], a[96:99], v[80:95]
    ds_read_b128 a[4:7], v142 offset:33792
    s_add_u32 s28, s27, 102400
    buffer_load_dwordx4 a[96:99], v142, s[12:15], s28 offen offset:0 sc1
    s_waitcnt lgkmcnt(6)
    v_mfma_f32_32x32x16_bf16 v[64:79], a[40:43], a[100:103], v[64:79]
    ds_read_b128 a[8:11], v142 offset:34816
    v_mfma_f32_32x32x16_bf16 v[80:95], a[44:47], a[100:103], v[80:95]
    ds_read_b128 a[12:15], v142 offset:35840
    buffer_load_dwordx4 a[100:103], v142, s[12:15], s28 offen offset:1024 sc1
    s_waitcnt lgkmcnt(6)
    v_mfma_f32_32x32x16_bf16 v[64:79], a[48:51], a[104:107], v[64:79]
    ds_read_b128 a[16:19], v142 offset:36864
    v_mfma_f32_32x32x16_bf16 v[80:95], a[52:55], a[104:107], v[80:95]
    ds_read_b128 a[20:23], v142 offset:37888
    buffer_load_dwordx4 a[104:107], v142, s[12:15], s28 offen offset:2048 sc1
    s_waitcnt lgkmcnt(6)
    v_mfma_f32_32x32x16_bf16 v[64:79], a[56:59], a[108:111], v[64:79]
    ds_read_b128 a[24:27], v142 offset:38912
    v_mfma_f32_32x32x16_bf16 v[80:95], a[60:63], a[108:111], v[80:95]
    ds_read_b128 a[28:31], v142 offset:39936
    buffer_load_dwordx4 a[108:111], v142, s[12:15], s28 offen offset:3072 sc1
    s_waitcnt vmcnt(20) lgkmcnt(6)
    v_mfma_f32_32x32x16_bf16 v[64:79], a[0:3], v[108:111], v[64:79]
    ds_read_b128 a[32:35], v142 offset:40960
    v_mfma_f32_32x32x16_bf16 v[80:95], a[4:7], v[108:111], v[80:95]
    ds_read_b128 a[36:39], v142 offset:41984
    s_add_u32 s28, s27, 106496
    buffer_load_dwordx4 v[108:111], v142, s[12:15], s28 offen offset:0 sc1
    s_waitcnt lgkmcnt(6)
    v_mfma_f32_32x32x16_bf16 v[64:79], a[8:11], v[112:115], v[64:79]
    ds_read_b128 a[40:43], v142 offset:43008
    v_mfma_f32_32x32x16_bf16 v[80:95], a[12:15], v[112:115], v[80:95]
    ds_read_b128 a[44:47], v142 offset:44032
    buffer_load_dwordx4 v[112:115], v142, s[12:15], s28 offen offset:1024 sc1
    s_waitcnt lgkmcnt(6)
    v_mfma_f32_32x32x16_bf16 v[64:79], a[16:19], v[116:119], v[64:79]
    ds_read_b128 a[48:51], v142 offset:45056
    v_mfma_f32_32x32x16_bf16 v[80:95], a[20:23], v[116:119], v[80:95]
    ds_read_b128 a[52:55], v142 offset:46080
    buffer_load_dwordx4 v[116:119], v142, s[12:15], s28 offen offset:2048 sc1
    s_waitcnt lgkmcnt(6)
    v_mfma_f32_32x32x16_bf16 v[64:79], a[24:27], v[120:123], v[64:79]
    ds_read_b128 a[56:59], v142 offset:47104
    v_mfma_f32_32x32x16_bf16 v[80:95], a[28:31], v[120:123], v[80:95]
    ds_read_b128 a[60:63], v142 offset:48128
    buffer_load_dwordx4 v[120:123], v142, s[12:15], s28 offen offset:3072 sc1
    s_barrier
    s_waitcnt vmcnt(20) lgkmcnt(6)
    v_mfma_f32_32x32x16_bf16 v[64:79], a[32:35], v[0:3], v[64:79]
    ds_read_b128 a[0:3], v142 offset:49152
    v_mfma_f32_32x32x16_bf16 v[80:95], a[36:39], v[0:3], v[80:95]
    ds_read_b128 a[4:7], v142 offset:50176
    s_add_u32 s28, s27, 110592
    buffer_load_dwordx4 v[0:3], v142, s[12:15], s28 offen offset:0 sc1
    s_waitcnt lgkmcnt(6)
    v_mfma_f32_32x32x16_bf16 v[64:79], a[40:43], v[4:7], v[64:79]
    ds_read_b128 a[8:11], v142 offset:51200
    v_mfma_f32_32x32x16_bf16 v[80:95], a[44:47], v[4:7], v[80:95]
    ds_read_b128 a[12:15], v142 offset:52224
    buffer_load_dwordx4 v[4:7], v142, s[12:15], s28 offen offset:1024 sc1
    s_waitcnt lgkmcnt(6)
    v_mfma_f32_32x32x16_bf16 v[64:79], a[48:51], v[8:11], v[64:79]
    ds_read_b128 a[16:19], v142 offset:53248
    v_mfma_f32_32x32x16_bf16 v[80:95], a[52:55], v[8:11], v[80:95]
    ds_read_b128 a[20:23], v142 offset:54272
    buffer_load_dwordx4 v[8:11], v142, s[12:15], s28 offen offset:2048 sc1
    s_waitcnt lgkmcnt(6)
    v_mfma_f32_32x32x16_bf16 v[64:79], a[56:59], v[12:15], v[64:79]
    ds_read_b128 a[24:27], v142 offset:55296
    v_mfma_f32_32x32x16_bf16 v[80:95], a[60:63], v[12:15], v[80:95]
    ds_read_b128 a[28:31], v142 offset:56320
    buffer_load_dwordx4 v[12:15], v142, s[12:15], s28 offen offset:3072 sc1
    s_waitcnt vmcnt(20) lgkmcnt(6)
    v_mfma_f32_32x32x16_bf16 v[64:79], a[0:3], v[16:19], v[64:79]
    ds_read_b128 a[32:35], v142 offset:57344
    v_mfma_f32_32x32x16_bf16 v[80:95], a[4:7], v[16:19], v[80:95]
    ds_read_b128 a[36:39], v142 offset:58368
    s_add_u32 s28, s27, 114688
    buffer_load_dwordx4 v[16:19], v142, s[12:15], s28 offen offset:0 sc1
    s_waitcnt lgkmcnt(6)
    v_mfma_f32_32x32x16_bf16 v[64:79], a[8:11], v[20:23], v[64:79]
    ds_read_b128 a[40:43], v142 offset:59392
    v_mfma_f32_32x32x16_bf16 v[80:95], a[12:15], v[20:23], v[80:95]
    ds_read_b128 a[44:47], v142 offset:60416
    buffer_load_dwordx4 v[20:23], v142, s[12:15], s28 offen offset:1024 sc1
    s_waitcnt lgkmcnt(6)
    v_mfma_f32_32x32x16_bf16 v[64:79], a[16:19], v[24:27], v[64:79]
    ds_read_b128 a[48:51], v142 offset:61440
    v_mfma_f32_32x32x16_bf16 v[80:95], a[20:23], v[24:27], v[80:95]
    ds_read_b128 a[52:55], v142 offset:62464
    buffer_load_dwordx4 v[24:27], v142, s[12:15], s28 offen offset:2048 sc1
    s_waitcnt lgkmcnt(6)
    v_mfma_f32_32x32x16_bf16 v[64:79], a[24:27], v[28:31], v[64:79]
    ds_read_b128 a[56:59], v142 offset:63488
    v_mfma_f32_32x32x16_bf16 v[80:95], a[28:31], v[28:31], v[80:95]
    ds_read_b128 a[60:63], v142 offset:64512
    buffer_load_dwordx4 v[28:31], v142, s[12:15], s28 offen offset:3072 sc1
    s_barrier
    s_waitcnt vmcnt(20) lgkmcnt(6)
    v_mfma_f32_32x32x16_bf16 v[64:79], a[32:35], a[80:83], v[64:79]
    ds_read_b128 a[0:3], v96 offset:0
    v_mfma_f32_32x32x16_bf16 v[80:95], a[36:39], a[80:83], v[80:95]
    ds_read_b128 a[4:7], v96 offset:1024
    s_add_u32 s28, s27, 118784
    buffer_load_dwordx4 a[80:83], v142, s[12:15], s28 offen offset:0 sc1
    s_waitcnt lgkmcnt(6)
    v_mfma_f32_32x32x16_bf16 v[64:79], a[40:43], a[84:87], v[64:79]
    ds_read_b128 a[8:11], v96 offset:2048
    v_mfma_f32_32x32x16_bf16 v[80:95], a[44:47], a[84:87], v[80:95]
    ds_read_b128 a[12:15], v96 offset:3072
    buffer_load_dwordx4 a[84:87], v142, s[12:15], s28 offen offset:1024 sc1
    s_waitcnt lgkmcnt(6)
    v_mfma_f32_32x32x16_bf16 v[64:79], a[48:51], a[88:91], v[64:79]
    ds_read_b128 a[16:19], v96 offset:4096
    v_mfma_f32_32x32x16_bf16 v[80:95], a[52:55], a[88:91], v[80:95]
    ds_read_b128 a[20:23], v96 offset:5120
    buffer_load_dwordx4 a[88:91], v142, s[12:15], s28 offen offset:2048 sc1
    s_waitcnt lgkmcnt(6)
    v_mfma_f32_32x32x16_bf16 v[64:79], a[56:59], a[92:95], v[64:79]
    ds_read_b128 a[24:27], v96 offset:6144
    v_mfma_f32_32x32x16_bf16 v[80:95], a[60:63], a[92:95], v[80:95]
    ds_read_b128 a[28:31], v96 offset:7168
    buffer_load_dwordx4 a[92:95], v142, s[12:15], s28 offen offset:3072 sc1
    s_waitcnt vmcnt(20) lgkmcnt(6)
    v_mfma_f32_32x32x16_bf16 v[64:79], a[0:3], a[64:67], v[64:79]
    ds_read_b128 a[32:35], v96 offset:8192
    v_mfma_f32_32x32x16_bf16 v[80:95], a[4:7], a[64:67], v[80:95]
    ds_read_b128 a[36:39], v96 offset:9216
    s_add_u32 s28, s27, 122880
    buffer_load_dwordx4 a[64:67], v142, s[12:15], s28 offen offset:0 sc1
    s_waitcnt lgkmcnt(6)
    v_mfma_f32_32x32x16_bf16 v[64:79], a[8:11], a[68:71], v[64:79]
    ds_read_b128 a[40:43], v96 offset:10240
    v_mfma_f32_32x32x16_bf16 v[80:95], a[12:15], a[68:71], v[80:95]
    ds_read_b128 a[44:47], v96 offset:11264
    buffer_load_dwordx4 a[68:71], v142, s[12:15], s28 offen offset:1024 sc1
    s_waitcnt lgkmcnt(6)
    v_mfma_f32_32x32x16_bf16 v[64:79], a[16:19], a[72:75], v[64:79]
    ds_read_b128 a[48:51], v96 offset:12288
    v_mfma_f32_32x32x16_bf16 v[80:95], a[20:23], a[72:75], v[80:95]
    ds_read_b128 a[52:55], v96 offset:13312
    buffer_load_dwordx4 a[72:75], v142, s[12:15], s28 offen offset:2048 sc1
    s_waitcnt lgkmcnt(6)
    v_mfma_f32_32x32x16_bf16 v[64:79], a[24:27], a[76:79], v[64:79]
    ds_read_b128 a[56:59], v96 offset:14336
    v_mfma_f32_32x32x16_bf16 v[80:95], a[28:31], a[76:79], v[80:95]
    ds_read_b128 a[60:63], v96 offset:15360
    buffer_load_dwordx4 a[76:79], v142, s[12:15], s28 offen offset:3072 sc1
    s_barrier
    s_waitcnt vmcnt(20) lgkmcnt(6)
    v_mfma_f32_32x32x16_bf16 v[64:79], a[32:35], a[96:99], v[64:79]
    ds_read_b128 a[0:3], v142 offset:32768
    v_mfma_f32_32x32x16_bf16 v[80:95], a[36:39], a[96:99], v[80:95]
    ds_read_b128 a[4:7], v142 offset:33792
    s_add_u32 s28, s27, 126976
    buffer_load_dwordx4 a[96:99], v142, s[12:15], s28 offen offset:0 sc1
    s_waitcnt lgkmcnt(6)
    v_mfma_f32_32x32x16_bf16 v[64:79], a[40:43], a[100:103], v[64:79]
    ds_read_b128 a[8:11], v142 offset:34816
    v_mfma_f32_32x32x16_bf16 v[80:95], a[44:47], a[100:103], v[80:95]
    ds_read_b128 a[12:15], v142 offset:35840
    buffer_load_dwordx4 a[100:103], v142, s[12:15], s28 offen offset:1024 sc1
    s_waitcnt lgkmcnt(6)
    v_mfma_f32_32x32x16_bf16 v[64:79], a[48:51], a[104:107], v[64:79]
    ds_read_b128 a[16:19], v142 offset:36864
    v_mfma_f32_32x32x16_bf16 v[80:95], a[52:55], a[104:107], v[80:95]
    ds_read_b128 a[20:23], v142 offset:37888
    buffer_load_dwordx4 a[104:107], v142, s[12:15], s28 offen offset:2048 sc1
    s_waitcnt lgkmcnt(6)
    v_mfma_f32_32x32x16_bf16 v[64:79], a[56:59], a[108:111], v[64:79]
    ds_read_b128 a[24:27], v142 offset:38912
    v_mfma_f32_32x32x16_bf16 v[80:95], a[60:63], a[108:111], v[80:95]
    ds_read_b128 a[28:31], v142 offset:39936
    buffer_load_dwordx4 a[108:111], v142, s[12:15], s28 offen offset:3072 sc1
    s_waitcnt vmcnt(20) lgkmcnt(6)
    v_mfma_f32_32x32x16_bf16 v[64:79], a[0:3], v[108:111], v[64:79]
    ds_read_b128 a[32:35], v142 offset:40960
    v_mfma_f32_32x32x16_bf16 v[80:95], a[4:7], v[108:111], v[80:95]
    ds_read_b128 a[36:39], v142 offset:41984
    s_waitcnt lgkmcnt(6)
    v_mfma_f32_32x32x16_bf16 v[64:79], a[8:11], v[112:115], v[64:79]
    ds_read_b128 a[40:43], v142 offset:43008
    v_mfma_f32_32x32x16_bf16 v[80:95], a[12:15], v[112:115], v[80:95]
    ds_read_b128 a[44:47], v142 offset:44032
    s_waitcnt lgkmcnt(6)
    v_mfma_f32_32x32x16_bf16 v[64:79], a[16:19], v[116:119], v[64:79]
    ds_read_b128 a[48:51], v142 offset:45056
    v_mfma_f32_32x32x16_bf16 v[80:95], a[20:23], v[116:119], v[80:95]
    ds_read_b128 a[52:55], v142 offset:46080
    s_waitcnt lgkmcnt(6)
    v_mfma_f32_32x32x16_bf16 v[64:79], a[24:27], v[120:123], v[64:79]
    ds_read_b128 a[56:59], v142 offset:47104
    v_mfma_f32_32x32x16_bf16 v[80:95], a[28:31], v[120:123], v[80:95]
    ds_read_b128 a[60:63], v142 offset:48128
    s_barrier
    s_waitcnt vmcnt(16) lgkmcnt(6)
    v_mfma_f32_32x32x16_bf16 v[64:79], a[32:35], v[0:3], v[64:79]
    ds_read_b128 a[0:3], v142 offset:49152
    v_mul_f32 v32, v32, v100
    v_mfma_f32_32x32x16_bf16 v[80:95], a[36:39], v[0:3], v[80:95]
    ds_read_b128 a[4:7], v142 offset:50176
    v_mul_f32 v33, v33, v100
    s_waitcnt lgkmcnt(6)
    v_mfma_f32_32x32x16_bf16 v[64:79], a[40:43], v[4:7], v[64:79]
    ds_read_b128 a[8:11], v142 offset:51200
    v_mul_f32 v34, v34, v100
    v_mfma_f32_32x32x16_bf16 v[80:95], a[44:47], v[4:7], v[80:95]
    ds_read_b128 a[12:15], v142 offset:52224
    v_mul_f32 v35, v35, v100
    s_waitcnt lgkmcnt(6)
    v_mfma_f32_32x32x16_bf16 v[64:79], a[48:51], v[8:11], v[64:79]
    ds_read_b128 a[16:19], v142 offset:53248
    v_mul_f32 v36, v36, v100
    v_mfma_f32_32x32x16_bf16 v[80:95], a[52:55], v[8:11], v[80:95]
    ds_read_b128 a[20:23], v142 offset:54272
    v_mul_f32 v37, v37, v100
    s_waitcnt lgkmcnt(6)
    v_mfma_f32_32x32x16_bf16 v[64:79], a[56:59], v[12:15], v[64:79]
    ds_read_b128 a[24:27], v142 offset:55296
    v_mul_f32 v38, v38, v100
    v_mfma_f32_32x32x16_bf16 v[80:95], a[60:63], v[12:15], v[80:95]
    ds_read_b128 a[28:31], v142 offset:56320
    v_mul_f32 v39, v39, v100
    s_waitcnt vmcnt(12) lgkmcnt(6)
    v_mfma_f32_32x32x16_bf16 v[64:79], a[0:3], v[16:19], v[64:79]
    ds_read_b128 a[32:35], v142 offset:57344
    v_mul_f32 v40, v40, v100
    v_mfma_f32_32x32x16_bf16 v[80:95], a[4:7], v[16:19], v[80:95]
    ds_read_b128 a[36:39], v142 offset:58368
    v_mul_f32 v41, v41, v100
    s_waitcnt lgkmcnt(6)
    v_mfma_f32_32x32x16_bf16 v[64:79], a[8:11], v[20:23], v[64:79]
    ds_read_b128 a[40:43], v142 offset:59392
    v_mul_f32 v42, v42, v100
    v_mfma_f32_32x32x16_bf16 v[80:95], a[12:15], v[20:23], v[80:95]
    ds_read_b128 a[44:47], v142 offset:60416
    v_mul_f32 v43, v43, v100
    s_waitcnt lgkmcnt(6)
    v_mfma_f32_32x32x16_bf16 v[64:79], a[16:19], v[24:27], v[64:79]
    ds_read_b128 a[48:51], v142 offset:61440
    v_mul_f32 v44, v44, v100
    v_mfma_f32_32x32x16_bf16 v[80:95], a[20:23], v[24:27], v[80:95]
    ds_read_b128 a[52:55], v142 offset:62464
    v_mul_f32 v45, v45, v100
    s_waitcnt lgkmcnt(6)
    v_mfma_f32_32x32x16_bf16 v[64:79], a[24:27], v[28:31], v[64:79]
    ds_read_b128 a[56:59], v142 offset:63488
    v_mul_f32 v46, v46, v100
    v_mfma_f32_32x32x16_bf16 v[80:95], a[28:31], v[28:31], v[80:95]
    ds_read_b128 a[60:63], v142 offset:64512
    v_mul_f32 v47, v47, v100
    s_barrier
    s_waitcnt vmcnt(8) lgkmcnt(6)
    v_mfma_f32_32x32x16_bf16 v[64:79], a[32:35], a[80:83], v[64:79]
    ds_read_b128 a[0:3], v96 offset:0
    v_mul_f32 v48, v48, v100
    v_mfma_f32_32x32x16_bf16 v[80:95], a[36:39], a[80:83], v[80:95]
    ds_read_b128 a[4:7], v96 offset:1024
    v_mul_f32 v49, v49, v100
    s_waitcnt lgkmcnt(6)
    v_mfma_f32_32x32x16_bf16 v[64:79], a[40:43], a[84:87], v[64:79]
    ds_read_b128 a[8:11], v96 offset:2048
    v_mul_f32 v50, v50, v100
    v_mfma_f32_32x32x16_bf16 v[80:95], a[44:47], a[84:87], v[80:95]
    ds_read_b128 a[12:15], v96 offset:3072
    v_mul_f32 v51, v51, v100
    s_waitcnt lgkmcnt(6)
    v_mfma_f32_32x32x16_bf16 v[64:79], a[48:51], a[88:91], v[64:79]
    ds_read_b128 a[16:19], v96 offset:4096
    v_mul_f32 v52, v52, v100
    v_mfma_f32_32x32x16_bf16 v[80:95], a[52:55], a[88:91], v[80:95]
    ds_read_b128 a[20:23], v96 offset:5120
    v_mul_f32 v53, v53, v100
    s_waitcnt lgkmcnt(6)
    v_mfma_f32_32x32x16_bf16 v[64:79], a[56:59], a[92:95], v[64:79]
    ds_read_b128 a[24:27], v96 offset:6144
    v_mul_f32 v54, v54, v100
    v_mfma_f32_32x32x16_bf16 v[80:95], a[60:63], a[92:95], v[80:95]
    ds_read_b128 a[28:31], v96 offset:7168
    v_mul_f32 v55, v55, v100
    s_waitcnt vmcnt(4) lgkmcnt(6)
    v_mfma_f32_32x32x16_bf16 v[64:79], a[0:3], a[64:67], v[64:79]
    ds_read_b128 a[32:35], v96 offset:8192
    v_mul_f32 v56, v56, v100
    v_mfma_f32_32x32x16_bf16 v[80:95], a[4:7], a[64:67], v[80:95]
    ds_read_b128 a[36:39], v96 offset:9216
    v_mul_f32 v57, v57, v100
    s_waitcnt lgkmcnt(6)
    v_mfma_f32_32x32x16_bf16 v[64:79], a[8:11], a[68:71], v[64:79]
    ds_read_b128 a[40:43], v96 offset:10240
    v_mul_f32 v58, v58, v100
    v_mfma_f32_32x32x16_bf16 v[80:95], a[12:15], a[68:71], v[80:95]
    ds_read_b128 a[44:47], v96 offset:11264
    v_mul_f32 v59, v59, v100
    s_waitcnt lgkmcnt(6)
    v_mfma_f32_32x32x16_bf16 v[64:79], a[16:19], a[72:75], v[64:79]
    ds_read_b128 a[48:51], v96 offset:12288
    v_mul_f32 v60, v60, v100
    v_mfma_f32_32x32x16_bf16 v[80:95], a[20:23], a[72:75], v[80:95]
    ds_read_b128 a[52:55], v96 offset:13312
    v_mul_f32 v61, v61, v100
    s_waitcnt lgkmcnt(6)
    v_mfma_f32_32x32x16_bf16 v[64:79], a[24:27], a[76:79], v[64:79]
    ds_read_b128 a[56:59], v96 offset:14336
    v_mul_f32 v62, v62, v100
    v_mfma_f32_32x32x16_bf16 v[80:95], a[28:31], a[76:79], v[80:95]
    ds_read_b128 a[60:63], v96 offset:15360
    v_mul_f32 v63, v63, v100
    s_waitcnt vmcnt(0) lgkmcnt(6)
    v_mfma_f32_32x32x16_bf16 v[64:79], a[32:35], a[96:99], v[64:79]
    v_mfma_f32_32x32x16_bf16 v[80:95], a[36:39], a[96:99], v[80:95]
    s_waitcnt lgkmcnt(4)
    v_mfma_f32_32x32x16_bf16 v[64:79], a[40:43], a[100:103], v[64:79]
    v_mfma_f32_32x32x16_bf16 v[80:95], a[44:47], a[100:103], v[80:95]
    s_waitcnt lgkmcnt(2)
    v_mfma_f32_32x32x16_bf16 v[64:79], a[48:51], a[104:107], v[64:79]
    v_mfma_f32_32x32x16_bf16 v[80:95], a[52:55], a[104:107], v[80:95]
    s_waitcnt lgkmcnt(0)
    v_mfma_f32_32x32x16_bf16 v[64:79], a[56:59], a[108:111], v[64:79]
    v_mfma_f32_32x32x16_bf16 v[80:95], a[60:63], a[108:111], v[80:95]
    s_nop 11
    v_fmac_f32 v32, v64, v101
    v_fmac_f32 v33, v65, v101
    v_fmac_f32 v34, v66, v101
    v_fmac_f32 v35, v67, v101
    v_fmac_f32 v36, v68, v101
    v_fmac_f32 v37, v69, v101
    v_fmac_f32 v38, v70, v101
    v_fmac_f32 v39, v71, v101
    v_fmac_f32 v40, v72, v101
    v_fmac_f32 v41, v73, v101
    v_fmac_f32 v42, v74, v101
    v_fmac_f32 v43, v75, v101
    v_fmac_f32 v44, v76, v101
    v_fmac_f32 v45, v77, v101
    v_fmac_f32 v46, v78, v101
    v_fmac_f32 v47, v79, v101
    v_cvt_pk_bf16_f32 v32, v32, v33
    v_cvt_pk_bf16_f32 v33, v34, v35
    v_cvt_pk_bf16_f32 v34, v36, v37
    v_cvt_pk_bf16_f32 v35, v38, v39
    v_cvt_pk_bf16_f32 v36, v40, v41
    v_cvt_pk_bf16_f32 v37, v42, v43
    v_cvt_pk_bf16_f32 v38, v44, v45
    v_cvt_pk_bf16_f32 v39, v46, v47
    buffer_store_dwordx4 v[32:35], v98, s[16:19], s36 offen offset:0
    buffer_store_dwordx4 v[36:39], v98, s[16:19], s36 offen offset:16
    v_fmac_f32 v48, v80, v101
    v_fmac_f32 v49, v81, v101
    v_fmac_f32 v50, v82, v101
    v_fmac_f32 v51, v83, v101
    v_fmac_f32 v52, v84, v101
    v_fmac_f32 v53, v85, v101
    v_fmac_f32 v54, v86, v101
    v_fmac_f32 v55, v87, v101
    v_fmac_f32 v56, v88, v101
    v_fmac_f32 v57, v89, v101
    v_fmac_f32 v58, v90, v101
    v_fmac_f32 v59, v91, v101
    v_fmac_f32 v60, v92, v101
    v_fmac_f32 v61, v93, v101
    v_fmac_f32 v62, v94, v101
    v_fmac_f32 v63, v95, v101
    v_cvt_pk_bf16_f32 v48, v48, v49
    v_cvt_pk_bf16_f32 v49, v50, v51
    v_cvt_pk_bf16_f32 v50, v52, v53
    v_cvt_pk_bf16_f32 v51, v54, v55
    v_cvt_pk_bf16_f32 v52, v56, v57
    v_cvt_pk_bf16_f32 v53, v58, v59
    v_cvt_pk_bf16_f32 v54, v60, v61
    v_cvt_pk_bf16_f32 v55, v62, v63
    buffer_store_dwordx4 v[48:51], v98, s[16:19], s36 offen offset:64
    buffer_store_dwordx4 v[52:55], v98, s[16:19], s36 offen offset:80
L_end:
    s_endpgm
L_codeend:

.section .rodata,"a"
.p2align 6
.amdhsa_kernel gated_mix__sliding_block__mha_block__prompt_kernel
  .amdhsa_next_free_vgpr 256
  .amdhsa_next_free_sgpr 102
  .amdhsa_accum_offset 144
  .amdhsa_group_segment_fixed_size 0
  .amdhsa_kernarg_size 80
  .amdhsa_user_sgpr_count 2
  .amdhsa_user_sgpr_kernarg_segment_ptr 1
  .amdhsa_system_sgpr_workgroup_id_x 1
.end_amdhsa_kernel
```
